```python
import torch

def _softmax(x, axis=-1):
    return torch.softmax(x, dim=axis)

def _gelu(x):
    return torch.nn.functional.gelu(x, approximate='tanh')

def _silu(x):
    return torch.nn.functional.silu(x)

def _sigmoid(x):
    return torch.sigmoid(x)

def _layernorm(x, axis=-1, eps=1e-05):
    m = x.mean(dim=axis, keepdim=True)
    v = x.var(dim=axis, keepdim=True, unbiased=False)
    return (x - m) / torch.sqrt(v + eps)

def _scatter_add(tgt, idx, src, axis=0):
    return tgt.clone().index_add_(axis, idx, src)

def _segment_sum(src, seg, n):
    out = torch.zeros((n,) + src.shape[1:], dtype=src.dtype)
    return out.index_add_(0, seg, src)

def _pad(x, pw):
    flat = tuple((v for pair in reversed(pw) for v in pair))
    return torch.nn.functional.pad(x, flat)
kernel_name = 'adaLN_cond__gqa_block_cached__geglu_ffn__decode'

def setup_inputs():

    _w = lambda a: (lambda t: t.to(torch.bfloat16) if t.is_floating_point() else t)(torch.as_tensor(a))

    def _A_setup():
        B, Sq, D = (1, 1, 512)
        Hq, Hkv, Sk, Dh = (32, 8, 65536, 128)
        assert Hq % Hkv == 0, (Hq, Hkv)
        return {'x': _w((lambda *s: torch.randn(*s, dtype=torch.bfloat16) * 0.05)(B, Sq, D)), 'k_cache': _w((lambda *s: torch.randn(*s, dtype=torch.bfloat16) * 3.2)(B, Hkv, Sk, Dh)), 'v_cache': _w((lambda *s: torch.randn(*s, dtype=torch.bfloat16) * 0.4)(B, Hkv, Sk, Dh)), 'wq': _w((lambda *s: torch.randn(*s, dtype=torch.bfloat16) * 3.2)(D, Hq * Dh) * D ** (-0.5)), 'wo': _w((lambda *s: torch.randn(*s, dtype=torch.bfloat16) * 0.4)(Hq * Dh, D) * (Hq * Dh) ** (-0.5))}
    _A_in = _A_setup()

    def _B_setup():
        B, S, D, F = (1, 1, 512, 1792)
        return {'x': _w((lambda *s: torch.randn(*s, dtype=torch.bfloat16) * 0.05)(B, S, D)), 'w_gate': _w((lambda *s: torch.randn(*s, dtype=torch.bfloat16) * 0.05)(D, F)), 'w_up': _w((lambda *s: torch.randn(*s, dtype=torch.bfloat16) * 0.05)(D, F)), 'w_down': _w((lambda *s: torch.randn(*s, dtype=torch.bfloat16) * 0.05)(F, D))}
    _B_in = _B_setup()
    return {'A_x': _A_in['x'], 'A_k_cache': _A_in['k_cache'], 'A_v_cache': _A_in['v_cache'], 'A_wq': _A_in['wq'], 'A_wo': _A_in['wo'], 'B_x': _B_in['x'], 'B_w_gate': _B_in['w_gate'], 'B_w_up': _B_in['w_up'], 'B_w_down': _B_in['w_down'], 'c': _w((lambda *s: torch.randn(*s, dtype=torch.bfloat16) * 0.2)(1, 512) * 8.0), 'w_mod': _w((lambda *s: torch.randn(*s, dtype=torch.bfloat16) * 0.2)(512, 6 * 512) * 512 ** (-0.5) * 8.0)}

def reference(A_x, A_k_cache, A_v_cache, A_wq, A_wo, B_x, B_w_gate, B_w_up, B_w_down, c, w_mod):

    def _A_ref(x, k_cache, v_cache, wq, wo):
        B, Sq, D = x.shape
        Hq, Dh = (32, 128)
        Hkv = k_cache.shape[1]
        rep = Hq // Hkv
        q = (lambda x, *d: x.permute(*d))((x @ wq).reshape(B, Sq, Hq, Dh), 0, 2, 1, 3)
        k = (lambda x, n, axis: torch.repeat_interleave(x, n, dim=axis))(k_cache, rep, axis=1)
        v = (lambda x, n, axis: torch.repeat_interleave(x, n, dim=axis))(v_cache, rep, axis=1)
        scores = torch.einsum('bhqd,bhkd->bhqk', q, k) * Dh ** (-0.5)
        p = _softmax(scores, axis=-1)
        o = torch.einsum('bhqk,bhkd->bhqd', p, v)
        return (lambda x, *d: x.permute(*d))(o, 0, 2, 1, 3).reshape(B, Sq, Hq * Dh) @ wo

    def _B_ref(x, w_gate, w_up, w_down):
        return _gelu(x @ w_gate) * (x @ w_up) @ w_down
    x = A_x
    mod = (_silu(c) @ w_mod).reshape(c.shape[0], 6, 1, -1)
    sa, ca, ga, sb, cb, gb = (mod[:, 0].clone(), mod[:, 1].clone(), mod[:, 2].clone(), mod[:, 3].clone(), mod[:, 4].clone(), mod[:, 5].clone())
    h = _layernorm(x, axis=-1) * (1 + ca) + sa
    x = x + ga * _A_ref(h, A_k_cache, A_v_cache, A_wq, A_wo)
    h = _layernorm(x, axis=-1) * (1 + cb) + sb
    x = x + gb * _B_ref(h, B_w_gate, B_w_up, B_w_down)
    return x
```

```asm
; @launch grid=(256,1,1) block=(512,1,1) lds=155648
.amdgcn_target "amdgcn-amd-amdhsa--gfx950"
.text
.globl adaLN_cond__gqa_block_cached__geglu_ffn__decode_kernel
.p2align 8
.type adaLN_cond__gqa_block_cached__geglu_ffn__decode_kernel,@function
adaLN_cond__gqa_block_cached__geglu_ffn__decode_kernel:
    s_cmp_ge_u32 s2, 256
    s_cbranch_scc1 L_end
    s_lshr_b32 s3, s2, 3
    s_sub_u32 s4, s2, 6
    s_and_b32 s4, s4, 7
    s_mul_i32 s5, s3, 7
    s_add_u32 s5, s5, s4
    s_add_u32 s5, s5, 31
    s_cmp_eq_u32 s4, 0
    s_cselect_b32 s2, s3, s5
    s_load_dwordx16 s[64:79], s[0:1], 0
    s_load_dwordx8 s[80:87], s[0:1], 64
    s_load_dwordx4 s[88:91], s[0:1], 96
    v_lshrrev_b32 v10, 6, v0
    v_and_b32 v1, 63, v0
    v_readfirstlane_b32 s3, v10
    v_lshlrev_b32 v4, 4, v1
    v_add_u32 v5, 4096, v4
    v_mov_b32 v12, 0
    s_mov_b32 s32, 0x05040100
    s_mov_b32 s33, 0x07060302
    s_mov_b32 s34, 0x3fb8aa3b
    s_mov_b32 s35, 0x3db504f3
    s_mov_b32 s43, s2
    s_cmp_lt_u32 s2, 32
    s_cbranch_scc1 L_service
    s_sub_u32 s30, s2, 32
    s_lshr_b32 s42, s30, 3
    s_and_b32 s41, s30, 7
L_sentry:
    s_mul_i32 s37, s42, 4
    s_add_u32 s37, s37, s3
    s_lshl_b32 s36, s42, 3
    s_add_u32 s36, s36, s3
    s_lshr_b32 s30, s3, 2
    s_mul_i32 s30, s30, 108
    s_add_u32 s37, s37, s30
    s_mul_i32 s38, s41, 136
    s_lshl_b32 s29, s41, 24
    v_bfe_u32 v2, v1, 2, 2
    v_lshlrev_b32 v2, 8, v2
    v_lshrrev_b32 v10, 4, v1
    v_lshl_add_u32 v2, v10, 6, v2
    v_and_b32 v11, 3, v1
    v_lshl_add_u32 v2, v11, 4, v2
    v_add_u32 v3, 4096, v2
    s_mov_b32 s30, s37
    s_add_u32 s30, s30, s38
    s_and_b32 s30, s30, 2047
    s_lshl_b32 s30, s30, 13
    s_add_u32 s28, s29, s30
    s_cmp_lg_u32 s3, 7
    s_cbranch_scc1 L_noclr
    v_mov_b32 v36, 0
    v_mov_b32 v37, 0
    v_mov_b32 v38, 0
    v_mov_b32 v39, 0
    ds_write_b128 v4, v[36:39] offset:20992
    ds_write_b128 v4, v[36:39] offset:22016
    v_lshlrev_b32 v11, 2, v1
    ds_write_b32 v11, v36 offset:20736
L_noclr:
    s_waitcnt lgkmcnt(0)
    s_mov_b32 s8, s66
    s_mov_b32 s9, s67
    s_mov_b32 s10, 0x8000000
    s_mov_b32 s11, 0x00020000
    s_mov_b32 s12, s68
    s_mov_b32 s13, s69
    s_mov_b32 s14, 0x8000000
    s_mov_b32 s15, 0x00020000
    s_mov_b32 s16, s90
    s_mov_b32 s17, s91
    s_mov_b32 s18, 0x20000000
    s_mov_b32 s19, 0x00020000
    s_cmp_lt_u32 s42, 8
    s_cbranch_scc1 L_efx
    s_cmp_eq_u32 s3, 7
    s_cbranch_scc1 L_efx
    buffer_load_dwordx4 v[116:119], v2, s[8:11], s28 offen offset:0 nt
    buffer_load_dwordx4 v[120:123], v2, s[8:11], s28 offen offset:1024 nt
    buffer_load_dwordx4 v[124:127], v2, s[8:11], s28 offen offset:2048 nt
    buffer_load_dwordx4 v[128:131], v2, s[8:11], s28 offen offset:3072 nt
    buffer_load_dwordx4 v[132:135], v3, s[8:11], s28 offen offset:0 nt
    buffer_load_dwordx4 v[136:139], v3, s[8:11], s28 offen offset:1024 nt
    buffer_load_dwordx4 v[140:143], v3, s[8:11], s28 offen offset:2048 nt
    buffer_load_dwordx4 v[144:147], v3, s[8:11], s28 offen offset:3072 nt
    s_load_dword s4, s[90:91], 0
    s_cmp_lt_u32 s3, 4
    s_cbranch_scc1 L_ef0
    s_setprio 2
    s_branch L_ef1
L_efx:
    s_load_dword s4, s[90:91], 0
    s_cmp_lt_u32 s42, 8
    s_cbranch_scc1 L_qhelp
    s_barrier
    s_branch L_poller2
L_qhelp:
    s_mov_b32 s20, s64
    s_mov_b32 s21, s65
    s_mov_b32 s22, 0x400
    s_mov_b32 s23, 0x00020000
    s_mov_b32 s24, s70
    s_mov_b32 s25, s71
    s_mov_b32 s26, 0x400000
    s_mov_b32 s27, 0x00020000
    v_bfe_u32 v15, v1, 3, 1
    v_lshl_add_u32 v15, v15, 2, v10
    v_lshlrev_b32 v15, 16, v15
    v_and_b32 v11, 7, v1
    v_lshl_add_u32 v15, v11, 4, v15
    s_lshl_b32 s28, s3, 19
    s_lshl_b32 s31, s41, 10
    s_add_u32 s28, s28, s31
    s_lshl_b32 s31, s42, 7
    s_add_u32 s28, s28, s31
    buffer_load_dwordx4 v[244:247], v4, s[20:23], 0 offen
    v_lshlrev_b32 v11, 1, v0
    buffer_load_ushort v6, v11, s[20:23], 0 offen
    buffer_load_dwordx4 v[52:55], v15, s[24:27], s28 offen nt
    s_add_u32 s30, s28, 8192
    buffer_load_dwordx4 v[56:59], v15, s[24:27], s30 offen nt
    s_add_u32 s30, s28, 16384
    buffer_load_dwordx4 v[60:63], v15, s[24:27], s30 offen nt
    s_add_u32 s30, s28, 24576
    buffer_load_dwordx4 v[64:67], v15, s[24:27], s30 offen nt
    s_add_u32 s30, s28, 32768
    buffer_load_dwordx4 v[68:71], v15, s[24:27], s30 offen nt
    s_add_u32 s30, s28, 40960
    buffer_load_dwordx4 v[72:75], v15, s[24:27], s30 offen nt
    s_add_u32 s30, s28, 49152
    buffer_load_dwordx4 v[76:79], v15, s[24:27], s30 offen nt
    s_add_u32 s30, s28, 57344
    buffer_load_dwordx4 v[80:83], v15, s[24:27], s30 offen nt
    v_mov_b32 v36, -1
    v_mov_b32 v37, -1
    v_mov_b32 v38, -1
    v_mov_b32 v39, -1
    s_lshl_b32 s30, s41, 16
    s_lshl_b32 s31, s36, 10
    s_add_u32 s30, s30, s31
    s_add_u32 s30, s30, 262144
    buffer_store_dwordx4 v[36:39], v4, s[16:19], s30 offen sc1
    s_cmp_lg_u32 s3, 7
    s_cbranch_scc1 L_clrdone
    v_lshrrev_b32 v11, 2, v1
    v_lshlrev_b32 v11, 8, v11
    v_and_b32 v13, 3, v1
    v_lshl_add_u32 v11, v13, 3, v11
    s_lshl_b32 s30, s41, 10
    s_lshl_b32 s31, s42, 5
    s_add_u32 s30, s30, s31
    s_add_u32 s30, s30, 196608
    v_mov_b32 v40, -1
    v_mov_b32 v41, -1
    s_mov_b64 exec, 0xffff
    buffer_store_dwordx2 v[40:41], v11, s[16:19], s30 offen sc1
    s_mul_i32 s30, s41, 4096
    s_mul_i32 s31, s42, 256
    s_add_u32 s30, s30, s31
    s_add_u32 s30, s30, 2097152
    s_mov_b64 exec, 1
    buffer_store_dword v12, v12, s[16:19], s30 offen sc1
    s_add_u32 s30, s30, 2048
    buffer_store_dword v12, v12, s[16:19], s30 offen sc1
    s_mov_b64 exec, -1
L_clrdone:
    v_and_b32 v13, 7, v1
    v_lshlrev_b32 v13, 5, v13
    v_lshl_add_u32 v13, v10, 3, v13
    s_lshl_b32 s31, s3, 8
    v_add_u32 v13, s31, v13
    v_and_b32 v7, 1, v1
    v_lshlrev_b32 v7, 6, v7
    v_lshl_add_u32 v7, v10, 4, v7
    s_lshl_b32 s30, s3, 7
    v_add_u32 v7, s30, v7
    v_lshlrev_b32 v15, 4, v0
    s_waitcnt lgkmcnt(0)
    s_mul_i32 s39, s4, 1664525
    s_add_u32 s39, s39, 1013904223
    s_or_b32 s39, s39, 1
    s_waitcnt vmcnt(9)
    v_lshlrev_b32 v6, 16, v6
    v_lshlrev_b32 v24, 16, v244
    v_and_b32 v25, 0xffff0000, v244
    v_lshlrev_b32 v26, 16, v245
    v_and_b32 v27, 0xffff0000, v245
    v_lshlrev_b32 v28, 16, v246
    v_and_b32 v29, 0xffff0000, v246
    v_lshlrev_b32 v30, 16, v247
    v_and_b32 v31, 0xffff0000, v247
    s_nop 0
    v_readfirstlane_b32 s48, v24
    s_nop 1
    v_subrev_f32 v24, s48, v24
    v_subrev_f32 v25, s48, v25
    v_subrev_f32 v26, s48, v26
    v_subrev_f32 v27, s48, v27
    v_subrev_f32 v28, s48, v28
    v_subrev_f32 v29, s48, v29
    v_subrev_f32 v30, s48, v30
    v_subrev_f32 v31, s48, v31
    v_add_f32 v8, v24, v25
    v_mul_f32 v9, v24, v24
    v_fmac_f32 v9, v25, v25
    v_add_f32 v8, v8, v26
    v_fmac_f32 v9, v26, v26
    v_add_f32 v8, v8, v27
    v_fmac_f32 v9, v27, v27
    v_add_f32 v8, v8, v28
    v_fmac_f32 v9, v28, v28
    v_add_f32 v8, v8, v29
    v_fmac_f32 v9, v29, v29
    v_add_f32 v8, v8, v30
    v_fmac_f32 v9, v30, v30
    v_add_f32 v8, v8, v31
    v_fmac_f32 v9, v31, v31
    s_nop 0
    s_nop 0
    v_add_f32_dpp v8, v8, v8 quad_perm:[1,0,3,2] row_mask:0xf bank_mask:0xf
    v_add_f32_dpp v9, v9, v9 quad_perm:[1,0,3,2] row_mask:0xf bank_mask:0xf
    s_nop 0
    v_add_f32_dpp v8, v8, v8 quad_perm:[2,3,0,1] row_mask:0xf bank_mask:0xf
    v_add_f32_dpp v9, v9, v9 quad_perm:[2,3,0,1] row_mask:0xf bank_mask:0xf
    s_nop 0
    v_add_f32_dpp v8, v8, v8 row_half_mirror row_mask:0xf bank_mask:0xf
    v_add_f32_dpp v9, v9, v9 row_half_mirror row_mask:0xf bank_mask:0xf
    s_nop 0
    v_add_f32_dpp v8, v8, v8 row_ror:8 row_mask:0xf bank_mask:0xf
    v_add_f32_dpp v9, v9, v9 row_ror:8 row_mask:0xf bank_mask:0xf
    v_mov_b32 v10, v8
    v_mov_b32 v11, v9
    s_nop 1
    v_permlane16_swap_b32 v8, v10
    v_permlane16_swap_b32 v9, v11
    v_add_f32 v8, v8, v10
    v_add_f32 v9, v9, v11
    v_mov_b32 v10, v8
    v_mov_b32 v11, v9
    s_nop 1
    v_permlane32_swap_b32 v8, v10
    v_permlane32_swap_b32 v9, v11
    v_add_f32 v8, v8, v10
    v_add_f32 v9, v9, v11
    v_mul_f32 v8, 0x3b000000, v8
    v_mul_f32 v9, 0x3b000000, v9
    v_fma_f32 v9, -v8, v8, v9
    v_max_f32 v9, 0, v9
    v_add_f32 v8, s48, v8
    v_cvt_pk_bf16_f32 v9, v9, v9
    v_and_b32 v9, 0xffff0000, v9
    v_cvt_pk_bf16_f32 v8, v8, v8
    v_and_b32 v8, 0xffff0000, v8
    v_add_f32 v9, 0x3727c5ac, v9
    v_sub_f32 v6, v6, v8
    v_cvt_pk_bf16_f32 v9, v9, v9
    v_and_b32 v9, 0xffff0000, v9
    v_cvt_pk_bf16_f32 v6, v6, v6
    v_and_b32 v6, 0xffff0000, v6
    v_sqrt_f32 v9, v9
    s_nop 0
    v_cvt_pk_bf16_f32 v9, v9, v9
    v_and_b32 v9, 0xffff0000, v9
    v_rcp_f32 v10, v9
    s_nop 0
    v_mul_f32 v11, v6, v10
    v_fma_f32 v6, -v11, v9, v6
    v_fma_f32 v6, v6, v10, v11
    v_cvt_pk_bf16_f32 v6, v6, v6
    v_and_b32 v6, 0xffff0000, v6
    s_waitcnt vmcnt(0)
    v_perm_b32 v84, v56, v52, s32
    v_perm_b32 v85, v64, v60, s32
    v_perm_b32 v86, v72, v68, s32
    v_perm_b32 v87, v80, v76, s32
    v_perm_b32 v88, v56, v52, s33
    v_perm_b32 v89, v64, v60, s33
    v_perm_b32 v90, v72, v68, s33
    v_perm_b32 v91, v80, v76, s33
    v_perm_b32 v92, v57, v53, s32
    v_perm_b32 v93, v65, v61, s32
    v_perm_b32 v94, v73, v69, s32
    v_perm_b32 v95, v81, v77, s32
    v_perm_b32 v96, v57, v53, s33
    v_perm_b32 v97, v65, v61, s33
    v_perm_b32 v98, v73, v69, s33
    v_perm_b32 v99, v81, v77, s33
    v_perm_b32 v100, v58, v54, s32
    v_perm_b32 v101, v66, v62, s32
    v_perm_b32 v102, v74, v70, s32
    v_perm_b32 v103, v82, v78, s32
    v_perm_b32 v104, v58, v54, s33
    v_perm_b32 v105, v66, v62, s33
    v_perm_b32 v106, v74, v70, s33
    v_perm_b32 v107, v82, v78, s33
    v_perm_b32 v108, v59, v55, s32
    v_perm_b32 v109, v67, v63, s32
    v_perm_b32 v110, v75, v71, s32
    v_perm_b32 v111, v83, v79, s32
    v_perm_b32 v112, v59, v55, s33
    v_perm_b32 v113, v67, v63, s33
    v_perm_b32 v114, v75, v71, s33
    v_perm_b32 v115, v83, v79, s33
    s_mov_b32 s49, 32768
    s_mov_b32 s50, 40960
    s_mov_b32 s40, 65536
L_poll1:
    buffer_load_dwordx4 v[36:39], v15, s[16:19], s49 offen sc1
    buffer_load_dwordx4 v[40:43], v15, s[16:19], s50 offen sc1
    s_waitcnt vmcnt(0)
    v_xor_b32 v10, s39, v37
    v_xor_b32 v11, s39, v39
    v_or_b32 v10, v10, v11
    v_xor_b32 v11, s39, v41
    v_or_b32 v10, v10, v11
    v_xor_b32 v11, s39, v43
    v_or_b32 v10, v10, v11
    v_cmp_ne_u32 vcc, 0, v10
    s_cbranch_vccz L_poll1ok
    s_sleep 16
    s_sub_u32 s40, s40, 1
    s_cmp_lg_u32 s40, 0
    s_cbranch_scc1 L_poll1
L_poll1ok:
    v_add_f32 v36, v36, v38
    v_add_f32 v40, v40, v42
    v_cvt_pk_bf16_f32 v40, v40, v40
    v_and_b32 v40, 0xffff0000, v40
    v_cvt_pk_bf16_f32 v36, v36, v36
    v_and_b32 v36, 0xffff0000, v36
    v_add_f32 v40, 1.0, v40
    v_cvt_pk_bf16_f32 v40, v40, v40
    v_and_b32 v40, 0xffff0000, v40
    v_mul_f32 v11, v6, v40
    v_cvt_pk_bf16_f32 v11, v11, v11
    v_and_b32 v11, 0xffff0000, v11
    v_add_f32 v11, v11, v36
    v_cvt_pk_bf16_f32 v11, v11, v11
    v_lshlrev_b32 v10, 1, v0
    ds_write_b16 v10, v11 offset:2048
    ds_read_b128 v[16:19], v7 offset:2048
    s_lshl_b32 s49, s41, 11
    s_lshl_b32 s31, s42, 8
    s_add_u32 s49, s49, s31
    s_add_u32 s49, s49, 81920
    s_waitcnt lgkmcnt(0)
    v_mfma_f32_16x16x32_bf16 v[52:55], v[16:19], v[84:87], 0
    v_mfma_f32_16x16x32_bf16 v[56:59], v[16:19], v[88:91], 0
    v_mfma_f32_16x16x32_bf16 v[60:63], v[16:19], v[92:95], 0
    v_mfma_f32_16x16x32_bf16 v[64:67], v[16:19], v[96:99], 0
    v_mfma_f32_16x16x32_bf16 v[68:71], v[16:19], v[100:103], 0
    v_mfma_f32_16x16x32_bf16 v[72:75], v[16:19], v[104:107], 0
    v_mfma_f32_16x16x32_bf16 v[76:79], v[16:19], v[108:111], 0
    v_mfma_f32_16x16x32_bf16 v[80:83], v[16:19], v[112:115], 0
    s_nop 0
    v_add_f32_dpp v24, v53, v52 row_ror:8 row_mask:0x1 bank_mask:0xf
    v_add_f32_dpp v25, v57, v56 row_ror:8 row_mask:0x1 bank_mask:0xf
    v_add_f32_dpp v24, v61, v60 row_ror:8 row_mask:0x2 bank_mask:0xf
    v_add_f32_dpp v25, v65, v64 row_ror:8 row_mask:0x2 bank_mask:0xf
    v_add_f32_dpp v24, v69, v68 row_ror:8 row_mask:0x4 bank_mask:0xf
    v_add_f32_dpp v25, v73, v72 row_ror:8 row_mask:0x4 bank_mask:0xf
    v_add_f32_dpp v24, v77, v76 row_ror:8 row_mask:0x8 bank_mask:0xf
    v_add_f32_dpp v25, v81, v80 row_ror:8 row_mask:0x8 bank_mask:0xf
    s_mov_b32 exec_lo, 0x00ff00ff
    s_mov_b32 exec_hi, 0x00ff00ff
    ds_write_b64 v13, v[24:25] offset:0
    s_mov_b64 exec, -1
    s_waitcnt lgkmcnt(0)
    s_barrier
    s_cmp_lg_u32 s3, 0
    s_cbranch_scc1 L_qskip
    s_mov_b64 exec, 0xffff
    ds_read_b128 v[52:55], v4 offset:0
    ds_read_b128 v[56:59], v4 offset:256
    ds_read_b128 v[60:63], v4 offset:512
    ds_read_b128 v[64:67], v4 offset:768
    ds_read_b128 v[68:71], v4 offset:1024
    ds_read_b128 v[72:75], v4 offset:1280
    ds_read_b128 v[76:79], v4 offset:1536
    ds_read_b128 v[80:83], v4 offset:1792
    s_waitcnt lgkmcnt(0)
    v_pk_add_f32 v[52:53], v[52:53], v[68:69]
    v_pk_add_f32 v[56:57], v[56:57], v[72:73]
    v_pk_add_f32 v[60:61], v[60:61], v[76:77]
    v_pk_add_f32 v[64:65], v[64:65], v[80:81]
    v_pk_add_f32 v[52:53], v[52:53], v[60:61]
    v_pk_add_f32 v[56:57], v[56:57], v[64:65]
    v_pk_add_f32 v[52:53], v[52:53], v[56:57]
    v_pk_add_f32 v[54:55], v[54:55], v[70:71]
    v_pk_add_f32 v[58:59], v[58:59], v[74:75]
    v_pk_add_f32 v[62:63], v[62:63], v[78:79]
    v_pk_add_f32 v[66:67], v[66:67], v[82:83]
    v_pk_add_f32 v[54:55], v[54:55], v[62:63]
    v_pk_add_f32 v[58:59], v[58:59], v[66:67]
    v_pk_add_f32 v[54:55], v[54:55], v[58:59]
    v_cvt_pk_bf16_f32 v24, v52, v53
    v_cvt_pk_bf16_f32 v26, v54, v55
    v_mov_b32 v25, s39
    v_mov_b32 v27, s39
    buffer_store_dwordx4 v[24:27], v4, s[16:19], s49 offen sc1
    s_mov_b64 exec, -1
    s_nop 1
L_qskip:
    s_barrier
L_pf1:
    s_cmp_eq_u32 s3, 7
    s_cbranch_scc1 L_poller
    s_cmp_ge_u32 s3, 4
    s_cbranch_scc1 L_pfh
    s_mov_b32 s30, s37
    s_add_u32 s30, s30, s38
    s_and_b32 s30, s30, 2047
    s_lshl_b32 s30, s30, 13
    s_add_u32 s28, s29, s30
    s_waitcnt vmcnt(7)
    buffer_load_dwordx4 v[116:119], v2, s[8:11], s28 offen offset:0 nt
    s_waitcnt vmcnt(7)
    buffer_load_dwordx4 v[120:123], v2, s[8:11], s28 offen offset:1024 nt
    s_waitcnt vmcnt(7)
    buffer_load_dwordx4 v[124:127], v2, s[8:11], s28 offen offset:2048 nt
    s_waitcnt vmcnt(7)
    buffer_load_dwordx4 v[128:131], v2, s[8:11], s28 offen offset:3072 nt
    s_waitcnt vmcnt(7)
    buffer_load_dwordx4 v[132:135], v3, s[8:11], s28 offen offset:0 nt
    s_waitcnt vmcnt(7)
    buffer_load_dwordx4 v[136:139], v3, s[8:11], s28 offen offset:1024 nt
    s_waitcnt vmcnt(7)
    buffer_load_dwordx4 v[140:143], v3, s[8:11], s28 offen offset:2048 nt
    s_waitcnt vmcnt(7)
    buffer_load_dwordx4 v[144:147], v3, s[8:11], s28 offen offset:3072 nt
L_ef0:
    s_barrier
    s_add_u32 s30, s37, 224
    s_add_u32 s30, s30, s38
    s_and_b32 s30, s30, 2047
    s_lshl_b32 s30, s30, 13
    s_add_u32 s28, s29, s30
    s_waitcnt vmcnt(7)
    buffer_load_dwordx4 v[148:151], v2, s[8:11], s28 offen offset:0 nt
    s_waitcnt vmcnt(7)
    buffer_load_dwordx4 v[152:155], v2, s[8:11], s28 offen offset:1024 nt
    s_waitcnt vmcnt(7)
    buffer_load_dwordx4 v[156:159], v2, s[8:11], s28 offen offset:2048 nt
    s_waitcnt vmcnt(7)
    buffer_load_dwordx4 v[160:163], v2, s[8:11], s28 offen offset:3072 nt
    s_waitcnt vmcnt(7)
    buffer_load_dwordx4 v[164:167], v3, s[8:11], s28 offen offset:0 nt
    s_waitcnt vmcnt(7)
    buffer_load_dwordx4 v[168:171], v3, s[8:11], s28 offen offset:1024 nt
    s_waitcnt vmcnt(7)
    buffer_load_dwordx4 v[172:175], v3, s[8:11], s28 offen offset:2048 nt
    s_waitcnt vmcnt(7)
    buffer_load_dwordx4 v[176:179], v3, s[8:11], s28 offen offset:3072 nt
    s_add_u32 s30, s37, 448
    s_add_u32 s30, s30, s38
    s_and_b32 s30, s30, 2047
    s_lshl_b32 s30, s30, 13
    s_add_u32 s28, s29, s30
    s_waitcnt vmcnt(7)
    buffer_load_dwordx4 v[180:183], v2, s[8:11], s28 offen offset:0 nt
    s_waitcnt vmcnt(7)
    buffer_load_dwordx4 v[184:187], v2, s[8:11], s28 offen offset:1024 nt
    s_waitcnt vmcnt(7)
    buffer_load_dwordx4 v[188:191], v2, s[8:11], s28 offen offset:2048 nt
    s_waitcnt vmcnt(7)
    buffer_load_dwordx4 v[192:195], v2, s[8:11], s28 offen offset:3072 nt
    s_waitcnt vmcnt(7)
    buffer_load_dwordx4 v[196:199], v3, s[8:11], s28 offen offset:0 nt
    s_waitcnt vmcnt(7)
    buffer_load_dwordx4 v[200:203], v3, s[8:11], s28 offen offset:1024 nt
    s_waitcnt vmcnt(7)
    buffer_load_dwordx4 v[204:207], v3, s[8:11], s28 offen offset:2048 nt
    s_waitcnt vmcnt(7)
    buffer_load_dwordx4 v[208:211], v3, s[8:11], s28 offen offset:3072 nt
    s_add_u32 s30, s37, 672
    s_add_u32 s30, s30, s38
    s_and_b32 s30, s30, 2047
    s_lshl_b32 s30, s30, 13
    s_add_u32 s28, s29, s30
    s_waitcnt vmcnt(7)
    buffer_load_dwordx4 v[212:215], v2, s[8:11], s28 offen offset:0 nt
    s_waitcnt vmcnt(7)
    buffer_load_dwordx4 v[216:219], v2, s[8:11], s28 offen offset:1024 nt
    s_waitcnt vmcnt(7)
    buffer_load_dwordx4 v[220:223], v2, s[8:11], s28 offen offset:2048 nt
    s_waitcnt vmcnt(7)
    buffer_load_dwordx4 v[224:227], v2, s[8:11], s28 offen offset:3072 nt
    s_waitcnt vmcnt(7)
    buffer_load_dwordx4 v[228:231], v3, s[8:11], s28 offen offset:0 nt
    s_waitcnt vmcnt(7)
    buffer_load_dwordx4 v[232:235], v3, s[8:11], s28 offen offset:1024 nt
    s_waitcnt vmcnt(7)
    buffer_load_dwordx4 v[236:239], v3, s[8:11], s28 offen offset:2048 nt
    s_waitcnt vmcnt(7)
    buffer_load_dwordx4 v[240:243], v3, s[8:11], s28 offen offset:3072 nt
    s_branch L_qwait
L_pfh:
    s_setprio 2
    s_mov_b32 s30, s37
    s_add_u32 s30, s30, s38
    s_and_b32 s30, s30, 2047
    s_lshl_b32 s30, s30, 13
    s_add_u32 s28, s29, s30
    s_waitcnt vmcnt(7)
    buffer_load_dwordx4 v[116:119], v2, s[8:11], s28 offen offset:0 nt
    s_waitcnt vmcnt(7)
    buffer_load_dwordx4 v[120:123], v2, s[8:11], s28 offen offset:1024 nt
    s_waitcnt vmcnt(7)
    buffer_load_dwordx4 v[124:127], v2, s[8:11], s28 offen offset:2048 nt
    s_waitcnt vmcnt(7)
    buffer_load_dwordx4 v[128:131], v2, s[8:11], s28 offen offset:3072 nt
    s_waitcnt vmcnt(7)
    buffer_load_dwordx4 v[132:135], v3, s[8:11], s28 offen offset:0 nt
    s_waitcnt vmcnt(7)
    buffer_load_dwordx4 v[136:139], v3, s[8:11], s28 offen offset:1024 nt
    s_waitcnt vmcnt(7)
    buffer_load_dwordx4 v[140:143], v3, s[8:11], s28 offen offset:2048 nt
    s_waitcnt vmcnt(7)
    buffer_load_dwordx4 v[144:147], v3, s[8:11], s28 offen offset:3072 nt
L_ef1:
    s_barrier
    s_add_u32 s30, s37, 224
    s_add_u32 s30, s30, s38
    s_and_b32 s30, s30, 2047
    s_lshl_b32 s30, s30, 13
    s_add_u32 s28, s29, s30
    s_waitcnt vmcnt(7)
    buffer_load_dwordx4 v[148:151], v2, s[8:11], s28 offen offset:0 nt
    s_waitcnt vmcnt(7)
    buffer_load_dwordx4 v[152:155], v2, s[8:11], s28 offen offset:1024 nt
    s_waitcnt vmcnt(7)
    buffer_load_dwordx4 v[156:159], v2, s[8:11], s28 offen offset:2048 nt
    s_waitcnt vmcnt(7)
    buffer_load_dwordx4 v[160:163], v2, s[8:11], s28 offen offset:3072 nt
    s_waitcnt vmcnt(7)
    buffer_load_dwordx4 v[164:167], v3, s[8:11], s28 offen offset:0 nt
    s_waitcnt vmcnt(7)
    buffer_load_dwordx4 v[168:171], v3, s[8:11], s28 offen offset:1024 nt
    s_waitcnt vmcnt(7)
    buffer_load_dwordx4 v[172:175], v3, s[8:11], s28 offen offset:2048 nt
    s_waitcnt vmcnt(7)
    buffer_load_dwordx4 v[176:179], v3, s[8:11], s28 offen offset:3072 nt
    s_add_u32 s30, s37, 448
    s_add_u32 s30, s30, s38
    s_and_b32 s30, s30, 2047
    s_lshl_b32 s30, s30, 13
    s_add_u32 s28, s29, s30
    s_waitcnt vmcnt(7)
    buffer_load_dwordx4 v[180:183], v2, s[8:11], s28 offen offset:0 nt
    s_waitcnt vmcnt(7)
    buffer_load_dwordx4 v[184:187], v2, s[8:11], s28 offen offset:1024 nt
    s_waitcnt vmcnt(7)
    buffer_load_dwordx4 v[188:191], v2, s[8:11], s28 offen offset:2048 nt
    s_waitcnt vmcnt(7)
    buffer_load_dwordx4 v[192:195], v2, s[8:11], s28 offen offset:3072 nt
    s_waitcnt vmcnt(7)
    buffer_load_dwordx4 v[196:199], v3, s[8:11], s28 offen offset:0 nt
    s_waitcnt vmcnt(7)
    buffer_load_dwordx4 v[200:203], v3, s[8:11], s28 offen offset:1024 nt
    s_waitcnt vmcnt(7)
    buffer_load_dwordx4 v[204:207], v3, s[8:11], s28 offen offset:2048 nt
    s_waitcnt vmcnt(7)
    buffer_load_dwordx4 v[208:211], v3, s[8:11], s28 offen offset:3072 nt
    s_add_u32 s30, s37, 672
    s_add_u32 s30, s30, s38
    s_and_b32 s30, s30, 2047
    s_lshl_b32 s30, s30, 13
    s_add_u32 s28, s29, s30
    s_waitcnt vmcnt(7)
    buffer_load_dwordx4 v[212:215], v2, s[8:11], s28 offen offset:0 nt
    s_waitcnt vmcnt(7)
    buffer_load_dwordx4 v[216:219], v2, s[8:11], s28 offen offset:1024 nt
    s_waitcnt vmcnt(7)
    buffer_load_dwordx4 v[220:223], v2, s[8:11], s28 offen offset:2048 nt
    s_waitcnt vmcnt(7)
    buffer_load_dwordx4 v[224:227], v2, s[8:11], s28 offen offset:3072 nt
    s_waitcnt vmcnt(7)
    buffer_load_dwordx4 v[228:231], v3, s[8:11], s28 offen offset:0 nt
    s_waitcnt vmcnt(7)
    buffer_load_dwordx4 v[232:235], v3, s[8:11], s28 offen offset:1024 nt
    s_waitcnt vmcnt(7)
    buffer_load_dwordx4 v[236:239], v3, s[8:11], s28 offen offset:2048 nt
    s_waitcnt vmcnt(7)
    buffer_load_dwordx4 v[240:243], v3, s[8:11], s28 offen offset:3072 nt
    s_cmp_lt_u32 s42, 8
    s_cbranch_scc1 L_qwait
    s_sub_u32 s30, s3, 4
    s_mul_i32 s51, s30, 16384
    s_add_u32 s51, s51, 24576
    s_mul_i32 s50, s42, 3
    s_add_u32 s50, s50, s30
    s_add_u32 s50, s50, 872
    s_add_u32 s30, s50, 0
    s_add_u32 s30, s30, s38
    s_and_b32 s30, s30, 2047
    s_lshl_b32 s30, s30, 13
    s_add_u32 s28, s29, s30
    s_add_u32 m0, s51, 0
    s_waitcnt vmcnt(7)
    buffer_load_dwordx4 v2, s[8:11], s28 offen offset:0 nt lds
    s_waitcnt vmcnt(7)
    buffer_load_dwordx4 v2, s[8:11], s28 offen offset:1024 nt lds
    s_waitcnt vmcnt(7)
    buffer_load_dwordx4 v2, s[8:11], s28 offen offset:2048 nt lds
    s_waitcnt vmcnt(7)
    buffer_load_dwordx4 v2, s[8:11], s28 offen offset:3072 nt lds
    s_add_u32 m0, s51, 4096
    s_waitcnt vmcnt(7)
    buffer_load_dwordx4 v3, s[8:11], s28 offen offset:0 nt lds
    s_waitcnt vmcnt(7)
    buffer_load_dwordx4 v3, s[8:11], s28 offen offset:1024 nt lds
    s_waitcnt vmcnt(7)
    buffer_load_dwordx4 v3, s[8:11], s28 offen offset:2048 nt lds
    s_waitcnt vmcnt(7)
    buffer_load_dwordx4 v3, s[8:11], s28 offen offset:3072 nt lds
    s_add_u32 s30, s50, 60
    s_add_u32 s30, s30, s38
    s_and_b32 s30, s30, 2047
    s_lshl_b32 s30, s30, 13
    s_add_u32 s28, s29, s30
    s_add_u32 m0, s51, 8192
    s_waitcnt vmcnt(7)
    buffer_load_dwordx4 v2, s[8:11], s28 offen offset:0 nt lds
    s_waitcnt vmcnt(7)
    buffer_load_dwordx4 v2, s[8:11], s28 offen offset:1024 nt lds
    s_waitcnt vmcnt(7)
    buffer_load_dwordx4 v2, s[8:11], s28 offen offset:2048 nt lds
    s_waitcnt vmcnt(7)
    buffer_load_dwordx4 v2, s[8:11], s28 offen offset:3072 nt lds
    s_add_u32 m0, s51, 12288
    s_waitcnt vmcnt(7)
    buffer_load_dwordx4 v3, s[8:11], s28 offen offset:0 nt lds
    s_waitcnt vmcnt(7)
    buffer_load_dwordx4 v3, s[8:11], s28 offen offset:1024 nt lds
    s_waitcnt vmcnt(7)
    buffer_load_dwordx4 v3, s[8:11], s28 offen offset:2048 nt lds
    s_waitcnt vmcnt(7)
    buffer_load_dwordx4 v3, s[8:11], s28 offen offset:3072 nt lds
    s_branch L_qwait
L_poller:
    s_barrier
L_poller2:
    s_setprio 3
    v_lshrrev_b32 v10, 4, v1
    v_and_b32 v11, 3, v1
    v_lshlrev_b32 v15, 9, v11
    v_lshl_add_u32 v15, v10, 7, v15
    v_bfe_u32 v11, v1, 2, 2
    v_lshl_add_u32 v15, v11, 5, v15
    s_lshl_b32 s49, s41, 11
    s_add_u32 s49, s49, 81920
    s_waitcnt lgkmcnt(0)
    s_mul_i32 s39, s4, 1664525
    s_add_u32 s39, s39, 1013904223
    s_or_b32 s39, s39, 1
    s_mov_b32 s40, 65536
    s_cmp_lt_u32 s42, 8
    s_cbranch_scc1 L_qpoll
    s_cmp_ge_u32 s42, 28
    s_cbranch_scc1 L_qpoll
    s_sleep 127
L_qpoll:
    buffer_load_dwordx4 v[36:39], v15, s[16:19], s49 offen sc1
    buffer_load_dwordx4 v[40:43], v15, s[16:19], s49 offen offset:16 sc1
    s_waitcnt vmcnt(0)
    v_xor_b32 v10, s39, v37
    v_xor_b32 v11, s39, v39
    v_or_b32 v10, v10, v11
    v_xor_b32 v11, s39, v41
    v_or_b32 v10, v10, v11
    v_xor_b32 v11, s39, v43
    v_or_b32 v10, v10, v11
    v_cmp_ne_u32 vcc, 0, v10
    s_cbranch_vccz L_qgot
    s_sleep 16
    s_sub_u32 s40, s40, 1
    s_cmp_lg_u32 s40, 0
    s_cbranch_scc1 L_qpoll
L_qgot:
    ds_write_b128 v4, v[36:39] offset:20992
    ds_write_b128 v4, v[40:43] offset:22016
    s_cmp_ge_u32 s42, 28
    s_cbranch_scc1 L_qwait
    s_mov_b32 s30, s37
    s_add_u32 s30, s30, s38
    s_and_b32 s30, s30, 2047
    s_lshl_b32 s30, s30, 13
    s_add_u32 s28, s29, s30
    s_waitcnt vmcnt(7)
    buffer_load_dwordx4 v[116:119], v2, s[8:11], s28 offen offset:0 nt
    s_waitcnt vmcnt(7)
    buffer_load_dwordx4 v[120:123], v2, s[8:11], s28 offen offset:1024 nt
    s_waitcnt vmcnt(7)
    buffer_load_dwordx4 v[124:127], v2, s[8:11], s28 offen offset:2048 nt
    s_waitcnt vmcnt(7)
    buffer_load_dwordx4 v[128:131], v2, s[8:11], s28 offen offset:3072 nt
    s_waitcnt vmcnt(7)
    buffer_load_dwordx4 v[132:135], v3, s[8:11], s28 offen offset:0 nt
    s_waitcnt vmcnt(7)
    buffer_load_dwordx4 v[136:139], v3, s[8:11], s28 offen offset:1024 nt
    s_waitcnt vmcnt(7)
    buffer_load_dwordx4 v[140:143], v3, s[8:11], s28 offen offset:2048 nt
    s_waitcnt vmcnt(7)
    buffer_load_dwordx4 v[144:147], v3, s[8:11], s28 offen offset:3072 nt
    s_add_u32 s30, s37, 224
    s_add_u32 s30, s30, s38
    s_and_b32 s30, s30, 2047
    s_lshl_b32 s30, s30, 13
    s_add_u32 s28, s29, s30
    s_waitcnt vmcnt(7)
    buffer_load_dwordx4 v[148:151], v2, s[8:11], s28 offen offset:0 nt
    s_waitcnt vmcnt(7)
    buffer_load_dwordx4 v[152:155], v2, s[8:11], s28 offen offset:1024 nt
    s_waitcnt vmcnt(7)
    buffer_load_dwordx4 v[156:159], v2, s[8:11], s28 offen offset:2048 nt
    s_waitcnt vmcnt(7)
    buffer_load_dwordx4 v[160:163], v2, s[8:11], s28 offen offset:3072 nt
    s_waitcnt vmcnt(7)
    buffer_load_dwordx4 v[164:167], v3, s[8:11], s28 offen offset:0 nt
    s_waitcnt vmcnt(7)
    buffer_load_dwordx4 v[168:171], v3, s[8:11], s28 offen offset:1024 nt
    s_waitcnt vmcnt(7)
    buffer_load_dwordx4 v[172:175], v3, s[8:11], s28 offen offset:2048 nt
    s_waitcnt vmcnt(7)
    buffer_load_dwordx4 v[176:179], v3, s[8:11], s28 offen offset:3072 nt
    s_add_u32 s30, s37, 448
    s_add_u32 s30, s30, s38
    s_and_b32 s30, s30, 2047
    s_lshl_b32 s30, s30, 13
    s_add_u32 s28, s29, s30
    s_waitcnt vmcnt(7)
    buffer_load_dwordx4 v[180:183], v2, s[8:11], s28 offen offset:0 nt
    s_waitcnt vmcnt(7)
    buffer_load_dwordx4 v[184:187], v2, s[8:11], s28 offen offset:1024 nt
    s_waitcnt vmcnt(7)
    buffer_load_dwordx4 v[188:191], v2, s[8:11], s28 offen offset:2048 nt
    s_waitcnt vmcnt(7)
    buffer_load_dwordx4 v[192:195], v2, s[8:11], s28 offen offset:3072 nt
    s_waitcnt vmcnt(7)
    buffer_load_dwordx4 v[196:199], v3, s[8:11], s28 offen offset:0 nt
    s_waitcnt vmcnt(7)
    buffer_load_dwordx4 v[200:203], v3, s[8:11], s28 offen offset:1024 nt
    s_waitcnt vmcnt(7)
    buffer_load_dwordx4 v[204:207], v3, s[8:11], s28 offen offset:2048 nt
    s_waitcnt vmcnt(7)
    buffer_load_dwordx4 v[208:211], v3, s[8:11], s28 offen offset:3072 nt
    s_add_u32 s30, s37, 672
    s_add_u32 s30, s30, s38
    s_and_b32 s30, s30, 2047
    s_lshl_b32 s30, s30, 13
    s_add_u32 s28, s29, s30
    s_waitcnt vmcnt(7)
    buffer_load_dwordx4 v[212:215], v2, s[8:11], s28 offen offset:0 nt
    s_waitcnt vmcnt(7)
    buffer_load_dwordx4 v[216:219], v2, s[8:11], s28 offen offset:1024 nt
    s_waitcnt vmcnt(7)
    buffer_load_dwordx4 v[220:223], v2, s[8:11], s28 offen offset:2048 nt
    s_waitcnt vmcnt(7)
    buffer_load_dwordx4 v[224:227], v2, s[8:11], s28 offen offset:3072 nt
    s_waitcnt vmcnt(7)
    buffer_load_dwordx4 v[228:231], v3, s[8:11], s28 offen offset:0 nt
    s_waitcnt vmcnt(7)
    buffer_load_dwordx4 v[232:235], v3, s[8:11], s28 offen offset:1024 nt
    s_waitcnt vmcnt(7)
    buffer_load_dwordx4 v[236:239], v3, s[8:11], s28 offen offset:2048 nt
    s_waitcnt vmcnt(7)
    buffer_load_dwordx4 v[240:243], v3, s[8:11], s28 offen offset:3072 nt
L_qwait:
    s_waitcnt lgkmcnt(0)
    s_mul_i32 s39, s4, 1664525
    s_add_u32 s39, s39, 1013904223
    s_or_b32 s39, s39, 1
    s_cmp_ge_u32 s3, 4
    s_cbranch_scc1 L_nozero
    v_mov_b32 v6, 0xff800000
    v_mov_b32 v7, 0
    v_mov_b32 v52, 0
    v_mov_b32 v53, 0
    v_mov_b32 v54, 0
    v_mov_b32 v55, 0
    v_mov_b32 v56, 0
    v_mov_b32 v57, 0
    v_mov_b32 v58, 0
    v_mov_b32 v59, 0
    v_mov_b32 v60, 0
    v_mov_b32 v61, 0
    v_mov_b32 v62, 0
    v_mov_b32 v63, 0
    v_mov_b32 v64, 0
    v_mov_b32 v65, 0
    v_mov_b32 v66, 0
    v_mov_b32 v67, 0
    v_mov_b32 v68, 0
    v_mov_b32 v69, 0
    v_mov_b32 v70, 0
    v_mov_b32 v71, 0
    v_mov_b32 v72, 0
    v_mov_b32 v73, 0
    v_mov_b32 v74, 0
    v_mov_b32 v75, 0
    v_mov_b32 v76, 0
    v_mov_b32 v77, 0
    v_mov_b32 v78, 0
    v_mov_b32 v79, 0
    v_mov_b32 v80, 0
    v_mov_b32 v81, 0
    v_mov_b32 v82, 0
    v_mov_b32 v83, 0
L_nozero:
    s_lshr_b32 s30, s42, 2
    s_add_u32 s5, s3, s30
    s_and_b32 s5, s5, 3
    s_and_b32 s30, s42, 3
    s_lshl_b32 s30, s30, 2
    s_add_u32 s5, s5, s30
    s_mul_i32 s31, s41, 4096
    s_mul_i32 s30, s5, 256
    s_add_u32 s31, s31, s30
    s_add_u32 s31, s31, 2097152
    v_mov_b32 v12, s31
    s_and_b32 s30, s3, 3
    s_lshl_b32 s28, s42, 2
    s_add_u32 s28, s28, s30
    s_mul_i32 s46, s30, 14336
    s_add_u32 s46, s46, 73728
    v_add_u32 v251, s46, v4
    s_cmp_lt_u32 s30, 3
    s_cselect_b32 s50, 6, 4
    s_cmp_lt_u32 s42, 8
    s_cselect_b32 s6, 32, 80
    s_cselect_b32 s31, 0, 64
    s_cselect_b32 s48, 3, 4
    s_cselect_b32 s50, 4, s50
    s_add_u32 s31, s31, s28
    s_add_u32 s31, s31, 1016
    s_add_u32 s49, s48, s50
    s_add_u32 s49, s49, 4
    v_mul_u32_u24 v250, s6, v1
    v_add_u32 v250, s31, v250
    s_mov_b32 s44, s48
    v_subrev_u32 v10, s44, v1
    v_mul_u32_u24 v10, 224, v10
    v_add_u32 v10, s28, v10
    v_cmp_le_u32 vcc, s44, v1
    v_cndmask_b32 v250, v250, v10, vcc
    s_add_u32 s44, s44, 4
    v_subrev_u32 v10, s44, v1
    v_mul_u32_u24 v10, s6, v10
    v_add_u32 v10, s31, v10
    v_cmp_le_u32 vcc, s44, v1
    v_cndmask_b32 v250, v250, v10, vcc
    s_add_u32 s44, s44, s48
    s_add_u32 s31, s28, 112
    v_subrev_u32 v10, s44, v1
    v_mul_u32_u24 v10, 224, v10
    v_add_u32 v10, s31, v10
    v_cmp_le_u32 vcc, s44, v1
    v_cndmask_b32 v250, v250, v10, vcc
    s_add_u32 s44, s44, 4
    s_sub_u32 s31, s28, s42
    s_add_u32 s31, s31, 872
    v_subrev_u32 v10, s44, v1
    v_mul_u32_u24 v10, 60, v10
    v_add_u32 v10, s31, v10
    v_cmp_le_u32 vcc, s44, v1
    v_cndmask_b32 v250, v250, v10, vcc
    s_add_u32 s44, s48, s49
    s_add_u32 s31, s28, 1432
    v_subrev_u32 v10, s44, v1
    v_mul_u32_u24 v10, 0, v10
    v_add_u32 v10, s31, v10
    v_cmp_le_u32 vcc, s44, v1
    v_cndmask_b32 v250, v250, v10, vcc
    v_add_u32 v250, s38, v250
    v_and_b32 v250, 2047, v250
    v_lshlrev_b32 v250, 13, v250
    v_add_u32 v250, s29, v250
    v_or_b32 v10, 1, v250
    v_cmp_ne_u32 vcc, s44, v1
    v_cndmask_b32 v10, v250, v10, vcc
    v_cmp_le_u32 vcc, s48, v1
    v_cndmask_b32 v250, v250, v10, vcc
    s_mov_b32 s37, 0
    s_lshl_b32 s30, s3, 3
    v_lshlrev_b32 v244, 6, v1
    v_add_u32 v244, s30, v244
    v_and_b32 v245, 3, v1
    v_mul_u32_u24 v245, 576, v245
    v_and_b32 v10, 48, v1
    v_add_u32 v245, v245, v10
    s_mul_i32 s30, s3, 2304
    v_add_u32 v245, s30, v245
    s_and_b32 s30, s3, 3
    s_lshl_b32 s30, s30, 2
    v_mov_b32 v246, s30
    v_mov_b32 v247, -1
    s_add_u32 s36, s5, 1688
    s_mov_b32 s40, 1048576
L_qlds:
    ds_read_b128 v[36:39], v4 offset:20992
    ds_read_b128 v[40:43], v4 offset:22016
    s_waitcnt lgkmcnt(0)
    v_xor_b32 v10, s39, v37
    v_xor_b32 v11, s39, v39
    v_or_b32 v10, v10, v11
    v_xor_b32 v11, s39, v41
    v_or_b32 v10, v10, v11
    v_xor_b32 v11, s39, v43
    v_or_b32 v10, v10, v11
    v_cmp_ne_u32 vcc, 0, v10
    s_cbranch_vccz L_qok
    s_sleep 1
    s_sub_u32 s40, s40, 1
    s_cmp_lg_u32 s40, 0
    s_cbranch_scc1 L_qlds
L_qok:
    v_mov_b32 v16, v36
    v_mov_b32 v17, v38
    v_mov_b32 v18, v40
    v_mov_b32 v19, v42
    s_cmp_ge_u32 s42, 28
    s_cbranch_scc1 L_hw
    s_cmp_lt_u32 s3, 4
    s_cbranch_scc1 L_steady
    s_lshl_b32 s30, s48, 10
    s_add_u32 s30, s30, 4096
    v_add_u32 v251, s30, v251
    s_waitcnt vmcnt(24)
    v_mfma_f32_16x16x32_bf16 v[84:87], v[116:119], v[16:19], 0
    v_mfma_f32_16x16x32_bf16 v[88:91], v[120:123], v[16:19], 0
    v_mfma_f32_16x16x32_bf16 v[92:95], v[124:127], v[16:19], 0
    v_mfma_f32_16x16x32_bf16 v[96:99], v[128:131], v[16:19], 0
    v_mfma_f32_16x16x32_bf16 v[100:103], v[132:135], v[16:19], 0
    v_mfma_f32_16x16x32_bf16 v[104:107], v[136:139], v[16:19], 0
    v_mfma_f32_16x16x32_bf16 v[108:111], v[140:143], v[16:19], 0
    v_mfma_f32_16x16x32_bf16 v[112:115], v[144:147], v[16:19], 0
    s_nop 7
    s_nop 1
    v_add_f32_dpp v84, v85, v84 row_ror:12 row_mask:0xf bank_mask:0xf
    v_add_f32_dpp v86, v87, v86 row_ror:12 row_mask:0xf bank_mask:0xf
    v_add_f32_dpp v88, v89, v88 row_ror:12 row_mask:0xf bank_mask:0xf
    v_add_f32_dpp v90, v91, v90 row_ror:12 row_mask:0xf bank_mask:0xf
    v_add_f32_dpp v92, v93, v92 row_ror:12 row_mask:0xf bank_mask:0xf
    v_add_f32_dpp v94, v95, v94 row_ror:12 row_mask:0xf bank_mask:0xf
    v_add_f32_dpp v96, v97, v96 row_ror:12 row_mask:0xf bank_mask:0xf
    v_add_f32_dpp v98, v99, v98 row_ror:12 row_mask:0xf bank_mask:0xf
    v_add_f32_dpp v100, v101, v100 row_ror:12 row_mask:0xf bank_mask:0xf
    v_add_f32_dpp v102, v103, v102 row_ror:12 row_mask:0xf bank_mask:0xf
    v_add_f32_dpp v104, v105, v104 row_ror:12 row_mask:0xf bank_mask:0xf
    v_add_f32_dpp v106, v107, v106 row_ror:12 row_mask:0xf bank_mask:0xf
    v_add_f32_dpp v108, v109, v108 row_ror:12 row_mask:0xf bank_mask:0xf
    v_add_f32_dpp v110, v111, v110 row_ror:12 row_mask:0xf bank_mask:0xf
    v_add_f32_dpp v112, v113, v112 row_ror:12 row_mask:0xf bank_mask:0xf
    v_add_f32_dpp v114, v115, v114 row_ror:12 row_mask:0xf bank_mask:0xf
    v_add_f32_dpp v24, v86, v84 row_ror:8 row_mask:0xf bank_mask:0xf
    v_add_f32_dpp v25, v90, v88 row_ror:8 row_mask:0xf bank_mask:0xf
    v_add_f32_dpp v26, v94, v92 row_ror:8 row_mask:0xf bank_mask:0xf
    v_add_f32_dpp v27, v98, v96 row_ror:8 row_mask:0xf bank_mask:0xf
    v_add_f32_dpp v28, v102, v100 row_ror:8 row_mask:0xf bank_mask:0xf
    v_add_f32_dpp v29, v106, v104 row_ror:8 row_mask:0xf bank_mask:0xf
    v_add_f32_dpp v30, v110, v108 row_ror:8 row_mask:0xf bank_mask:0xf
    v_add_f32_dpp v31, v114, v112 row_ror:8 row_mask:0xf bank_mask:0xf
    v_cvt_pk_bf16_f32 v32, v24, v25
    v_cvt_pk_bf16_f32 v33, v26, v27
    v_cvt_pk_bf16_f32 v34, v28, v29
    v_cvt_pk_bf16_f32 v35, v30, v31
    v_lshlrev_b32 v24, 16, v32
    v_and_b32 v25, 0xffff0000, v32
    v_lshlrev_b32 v26, 16, v33
    v_and_b32 v27, 0xffff0000, v33
    v_lshlrev_b32 v28, 16, v34
    v_and_b32 v29, 0xffff0000, v34
    v_lshlrev_b32 v30, 16, v35
    v_and_b32 v31, 0xffff0000, v35
    v_mul_f32 v24, s35, v24
    v_mul_f32 v25, s35, v25
    v_mul_f32 v26, s35, v26
    v_mul_f32 v27, s35, v27
    v_mul_f32 v28, s35, v28
    v_mul_f32 v29, s35, v29
    v_mul_f32 v30, s35, v30
    v_mul_f32 v31, s35, v31
    v_cvt_pk_bf16_f32 v32, v24, v25
    v_cvt_pk_bf16_f32 v33, v26, v27
    v_cvt_pk_bf16_f32 v34, v28, v29
    v_cvt_pk_bf16_f32 v35, v30, v31
    ds_write_b128 v251, v[32:35]
    v_add_u32 v251, 1024, v251
    s_waitcnt vmcnt(16)
    v_mfma_f32_16x16x32_bf16 v[84:87], v[148:151], v[16:19], 0
    v_mfma_f32_16x16x32_bf16 v[88:91], v[152:155], v[16:19], 0
    v_mfma_f32_16x16x32_bf16 v[92:95], v[156:159], v[16:19], 0
    v_mfma_f32_16x16x32_bf16 v[96:99], v[160:163], v[16:19], 0
    v_mfma_f32_16x16x32_bf16 v[100:103], v[164:167], v[16:19], 0
    v_mfma_f32_16x16x32_bf16 v[104:107], v[168:171], v[16:19], 0
    v_mfma_f32_16x16x32_bf16 v[108:111], v[172:175], v[16:19], 0
    v_mfma_f32_16x16x32_bf16 v[112:115], v[176:179], v[16:19], 0
    s_nop 7
    s_nop 1
    v_add_f32_dpp v84, v85, v84 row_ror:12 row_mask:0xf bank_mask:0xf
    v_add_f32_dpp v86, v87, v86 row_ror:12 row_mask:0xf bank_mask:0xf
    v_add_f32_dpp v88, v89, v88 row_ror:12 row_mask:0xf bank_mask:0xf
    v_add_f32_dpp v90, v91, v90 row_ror:12 row_mask:0xf bank_mask:0xf
    v_add_f32_dpp v92, v93, v92 row_ror:12 row_mask:0xf bank_mask:0xf
    v_add_f32_dpp v94, v95, v94 row_ror:12 row_mask:0xf bank_mask:0xf
    v_add_f32_dpp v96, v97, v96 row_ror:12 row_mask:0xf bank_mask:0xf
    v_add_f32_dpp v98, v99, v98 row_ror:12 row_mask:0xf bank_mask:0xf
    v_add_f32_dpp v100, v101, v100 row_ror:12 row_mask:0xf bank_mask:0xf
    v_add_f32_dpp v102, v103, v102 row_ror:12 row_mask:0xf bank_mask:0xf
    v_add_f32_dpp v104, v105, v104 row_ror:12 row_mask:0xf bank_mask:0xf
    v_add_f32_dpp v106, v107, v106 row_ror:12 row_mask:0xf bank_mask:0xf
    v_add_f32_dpp v108, v109, v108 row_ror:12 row_mask:0xf bank_mask:0xf
    v_add_f32_dpp v110, v111, v110 row_ror:12 row_mask:0xf bank_mask:0xf
    v_add_f32_dpp v112, v113, v112 row_ror:12 row_mask:0xf bank_mask:0xf
    v_add_f32_dpp v114, v115, v114 row_ror:12 row_mask:0xf bank_mask:0xf
    v_add_f32_dpp v24, v86, v84 row_ror:8 row_mask:0xf bank_mask:0xf
    v_add_f32_dpp v25, v90, v88 row_ror:8 row_mask:0xf bank_mask:0xf
    v_add_f32_dpp v26, v94, v92 row_ror:8 row_mask:0xf bank_mask:0xf
    v_add_f32_dpp v27, v98, v96 row_ror:8 row_mask:0xf bank_mask:0xf
    v_add_f32_dpp v28, v102, v100 row_ror:8 row_mask:0xf bank_mask:0xf
    v_add_f32_dpp v29, v106, v104 row_ror:8 row_mask:0xf bank_mask:0xf
    v_add_f32_dpp v30, v110, v108 row_ror:8 row_mask:0xf bank_mask:0xf
    v_add_f32_dpp v31, v114, v112 row_ror:8 row_mask:0xf bank_mask:0xf
    v_cvt_pk_bf16_f32 v32, v24, v25
    v_cvt_pk_bf16_f32 v33, v26, v27
    v_cvt_pk_bf16_f32 v34, v28, v29
    v_cvt_pk_bf16_f32 v35, v30, v31
    v_lshlrev_b32 v24, 16, v32
    v_and_b32 v25, 0xffff0000, v32
    v_lshlrev_b32 v26, 16, v33
    v_and_b32 v27, 0xffff0000, v33
    v_lshlrev_b32 v28, 16, v34
    v_and_b32 v29, 0xffff0000, v34
    v_lshlrev_b32 v30, 16, v35
    v_and_b32 v31, 0xffff0000, v35
    v_mul_f32 v24, s35, v24
    v_mul_f32 v25, s35, v25
    v_mul_f32 v26, s35, v26
    v_mul_f32 v27, s35, v27
    v_mul_f32 v28, s35, v28
    v_mul_f32 v29, s35, v29
    v_mul_f32 v30, s35, v30
    v_mul_f32 v31, s35, v31
    v_cvt_pk_bf16_f32 v32, v24, v25
    v_cvt_pk_bf16_f32 v33, v26, v27
    v_cvt_pk_bf16_f32 v34, v28, v29
    v_cvt_pk_bf16_f32 v35, v30, v31
    ds_write_b128 v251, v[32:35]
    v_add_u32 v251, 1024, v251
    s_waitcnt vmcnt(8)
    v_mfma_f32_16x16x32_bf16 v[84:87], v[180:183], v[16:19], 0
    v_mfma_f32_16x16x32_bf16 v[88:91], v[184:187], v[16:19], 0
    v_mfma_f32_16x16x32_bf16 v[92:95], v[188:191], v[16:19], 0
    v_mfma_f32_16x16x32_bf16 v[96:99], v[192:195], v[16:19], 0
    v_mfma_f32_16x16x32_bf16 v[100:103], v[196:199], v[16:19], 0
    v_mfma_f32_16x16x32_bf16 v[104:107], v[200:203], v[16:19], 0
    v_mfma_f32_16x16x32_bf16 v[108:111], v[204:207], v[16:19], 0
    v_mfma_f32_16x16x32_bf16 v[112:115], v[208:211], v[16:19], 0
    s_nop 7
    s_nop 1
    v_add_f32_dpp v84, v85, v84 row_ror:12 row_mask:0xf bank_mask:0xf
    v_add_f32_dpp v86, v87, v86 row_ror:12 row_mask:0xf bank_mask:0xf
    v_add_f32_dpp v88, v89, v88 row_ror:12 row_mask:0xf bank_mask:0xf
    v_add_f32_dpp v90, v91, v90 row_ror:12 row_mask:0xf bank_mask:0xf
    v_add_f32_dpp v92, v93, v92 row_ror:12 row_mask:0xf bank_mask:0xf
    v_add_f32_dpp v94, v95, v94 row_ror:12 row_mask:0xf bank_mask:0xf
    v_add_f32_dpp v96, v97, v96 row_ror:12 row_mask:0xf bank_mask:0xf
    v_add_f32_dpp v98, v99, v98 row_ror:12 row_mask:0xf bank_mask:0xf
    v_add_f32_dpp v100, v101, v100 row_ror:12 row_mask:0xf bank_mask:0xf
    v_add_f32_dpp v102, v103, v102 row_ror:12 row_mask:0xf bank_mask:0xf
    v_add_f32_dpp v104, v105, v104 row_ror:12 row_mask:0xf bank_mask:0xf
    v_add_f32_dpp v106, v107, v106 row_ror:12 row_mask:0xf bank_mask:0xf
    v_add_f32_dpp v108, v109, v108 row_ror:12 row_mask:0xf bank_mask:0xf
    v_add_f32_dpp v110, v111, v110 row_ror:12 row_mask:0xf bank_mask:0xf
    v_add_f32_dpp v112, v113, v112 row_ror:12 row_mask:0xf bank_mask:0xf
    v_add_f32_dpp v114, v115, v114 row_ror:12 row_mask:0xf bank_mask:0xf
    v_add_f32_dpp v24, v86, v84 row_ror:8 row_mask:0xf bank_mask:0xf
    v_add_f32_dpp v25, v90, v88 row_ror:8 row_mask:0xf bank_mask:0xf
    v_add_f32_dpp v26, v94, v92 row_ror:8 row_mask:0xf bank_mask:0xf
    v_add_f32_dpp v27, v98, v96 row_ror:8 row_mask:0xf bank_mask:0xf
    v_add_f32_dpp v28, v102, v100 row_ror:8 row_mask:0xf bank_mask:0xf
    v_add_f32_dpp v29, v106, v104 row_ror:8 row_mask:0xf bank_mask:0xf
    v_add_f32_dpp v30, v110, v108 row_ror:8 row_mask:0xf bank_mask:0xf
    v_add_f32_dpp v31, v114, v112 row_ror:8 row_mask:0xf bank_mask:0xf
    v_cvt_pk_bf16_f32 v32, v24, v25
    v_cvt_pk_bf16_f32 v33, v26, v27
    v_cvt_pk_bf16_f32 v34, v28, v29
    v_cvt_pk_bf16_f32 v35, v30, v31
    v_lshlrev_b32 v24, 16, v32
    v_and_b32 v25, 0xffff0000, v32
    v_lshlrev_b32 v26, 16, v33
    v_and_b32 v27, 0xffff0000, v33
    v_lshlrev_b32 v28, 16, v34
    v_and_b32 v29, 0xffff0000, v34
    v_lshlrev_b32 v30, 16, v35
    v_and_b32 v31, 0xffff0000, v35
    v_mul_f32 v24, s35, v24
    v_mul_f32 v25, s35, v25
    v_mul_f32 v26, s35, v26
    v_mul_f32 v27, s35, v27
    v_mul_f32 v28, s35, v28
    v_mul_f32 v29, s35, v29
    v_mul_f32 v30, s35, v30
    v_mul_f32 v31, s35, v31
    v_cvt_pk_bf16_f32 v32, v24, v25
    v_cvt_pk_bf16_f32 v33, v26, v27
    v_cvt_pk_bf16_f32 v34, v28, v29
    v_cvt_pk_bf16_f32 v35, v30, v31
    ds_write_b128 v251, v[32:35]
    v_add_u32 v251, 1024, v251
    s_waitcnt vmcnt(0)
    v_mfma_f32_16x16x32_bf16 v[84:87], v[212:215], v[16:19], 0
    v_mfma_f32_16x16x32_bf16 v[88:91], v[216:219], v[16:19], 0
    v_mfma_f32_16x16x32_bf16 v[92:95], v[220:223], v[16:19], 0
    v_mfma_f32_16x16x32_bf16 v[96:99], v[224:227], v[16:19], 0
    v_mfma_f32_16x16x32_bf16 v[100:103], v[228:231], v[16:19], 0
    v_mfma_f32_16x16x32_bf16 v[104:107], v[232:235], v[16:19], 0
    v_mfma_f32_16x16x32_bf16 v[108:111], v[236:239], v[16:19], 0
    v_mfma_f32_16x16x32_bf16 v[112:115], v[240:243], v[16:19], 0
    s_nop 7
    s_nop 1
    v_add_f32_dpp v84, v85, v84 row_ror:12 row_mask:0xf bank_mask:0xf
    v_add_f32_dpp v86, v87, v86 row_ror:12 row_mask:0xf bank_mask:0xf
    v_add_f32_dpp v88, v89, v88 row_ror:12 row_mask:0xf bank_mask:0xf
    v_add_f32_dpp v90, v91, v90 row_ror:12 row_mask:0xf bank_mask:0xf
    v_add_f32_dpp v92, v93, v92 row_ror:12 row_mask:0xf bank_mask:0xf
    v_add_f32_dpp v94, v95, v94 row_ror:12 row_mask:0xf bank_mask:0xf
    v_add_f32_dpp v96, v97, v96 row_ror:12 row_mask:0xf bank_mask:0xf
    v_add_f32_dpp v98, v99, v98 row_ror:12 row_mask:0xf bank_mask:0xf
    v_add_f32_dpp v100, v101, v100 row_ror:12 row_mask:0xf bank_mask:0xf
    v_add_f32_dpp v102, v103, v102 row_ror:12 row_mask:0xf bank_mask:0xf
    v_add_f32_dpp v104, v105, v104 row_ror:12 row_mask:0xf bank_mask:0xf
    v_add_f32_dpp v106, v107, v106 row_ror:12 row_mask:0xf bank_mask:0xf
    v_add_f32_dpp v108, v109, v108 row_ror:12 row_mask:0xf bank_mask:0xf
    v_add_f32_dpp v110, v111, v110 row_ror:12 row_mask:0xf bank_mask:0xf
    v_add_f32_dpp v112, v113, v112 row_ror:12 row_mask:0xf bank_mask:0xf
    v_add_f32_dpp v114, v115, v114 row_ror:12 row_mask:0xf bank_mask:0xf
    v_add_f32_dpp v24, v86, v84 row_ror:8 row_mask:0xf bank_mask:0xf
    v_add_f32_dpp v25, v90, v88 row_ror:8 row_mask:0xf bank_mask:0xf
    v_add_f32_dpp v26, v94, v92 row_ror:8 row_mask:0xf bank_mask:0xf
    v_add_f32_dpp v27, v98, v96 row_ror:8 row_mask:0xf bank_mask:0xf
    v_add_f32_dpp v28, v102, v100 row_ror:8 row_mask:0xf bank_mask:0xf
    v_add_f32_dpp v29, v106, v104 row_ror:8 row_mask:0xf bank_mask:0xf
    v_add_f32_dpp v30, v110, v108 row_ror:8 row_mask:0xf bank_mask:0xf
    v_add_f32_dpp v31, v114, v112 row_ror:8 row_mask:0xf bank_mask:0xf
    v_cvt_pk_bf16_f32 v32, v24, v25
    v_cvt_pk_bf16_f32 v33, v26, v27
    v_cvt_pk_bf16_f32 v34, v28, v29
    v_cvt_pk_bf16_f32 v35, v30, v31
    v_lshlrev_b32 v24, 16, v32
    v_and_b32 v25, 0xffff0000, v32
    v_lshlrev_b32 v26, 16, v33
    v_and_b32 v27, 0xffff0000, v33
    v_lshlrev_b32 v28, 16, v34
    v_and_b32 v29, 0xffff0000, v34
    v_lshlrev_b32 v30, 16, v35
    v_and_b32 v31, 0xffff0000, v35
    v_mul_f32 v24, s35, v24
    v_mul_f32 v25, s35, v25
    v_mul_f32 v26, s35, v26
    v_mul_f32 v27, s35, v27
    v_mul_f32 v28, s35, v28
    v_mul_f32 v29, s35, v29
    v_mul_f32 v30, s35, v30
    v_mul_f32 v31, s35, v31
    v_cvt_pk_bf16_f32 v32, v24, v25
    v_cvt_pk_bf16_f32 v33, v26, v27
    v_cvt_pk_bf16_f32 v34, v28, v29
    v_cvt_pk_bf16_f32 v35, v30, v31
    ds_write_b128 v251, v[32:35]
    v_add_u32 v251, 1024, v251
    s_cmp_eq_u32 s50, 4
    s_cbranch_scc1 L_hk2
    v_add_u32 v15, s51, v4
    ds_read_b128 v[180:183], v15 offset:0
    ds_read_b128 v[184:187], v15 offset:1024
    ds_read_b128 v[188:191], v15 offset:2048
    ds_read_b128 v[192:195], v15 offset:3072
    ds_read_b128 v[196:199], v15 offset:4096
    ds_read_b128 v[200:203], v15 offset:5120
    ds_read_b128 v[204:207], v15 offset:6144
    ds_read_b128 v[208:211], v15 offset:7168
    s_waitcnt lgkmcnt(0)
    ds_read_b128 v[212:215], v15 offset:8192
    ds_read_b128 v[216:219], v15 offset:9216
    ds_read_b128 v[220:223], v15 offset:10240
    ds_read_b128 v[224:227], v15 offset:11264
    ds_read_b128 v[228:231], v15 offset:12288
    ds_read_b128 v[232:235], v15 offset:13312
    ds_read_b128 v[236:239], v15 offset:14336
    ds_read_b128 v[240:243], v15 offset:15360
    v_mfma_f32_16x16x32_bf16 v[84:87], v[180:183], v[16:19], 0
    v_mfma_f32_16x16x32_bf16 v[88:91], v[184:187], v[16:19], 0
    v_mfma_f32_16x16x32_bf16 v[92:95], v[188:191], v[16:19], 0
    v_mfma_f32_16x16x32_bf16 v[96:99], v[192:195], v[16:19], 0
    v_mfma_f32_16x16x32_bf16 v[100:103], v[196:199], v[16:19], 0
    v_mfma_f32_16x16x32_bf16 v[104:107], v[200:203], v[16:19], 0
    v_mfma_f32_16x16x32_bf16 v[108:111], v[204:207], v[16:19], 0
    v_mfma_f32_16x16x32_bf16 v[112:115], v[208:211], v[16:19], 0
    s_nop 7
    s_nop 1
    v_add_f32_dpp v84, v85, v84 row_ror:12 row_mask:0xf bank_mask:0xf
    v_add_f32_dpp v86, v87, v86 row_ror:12 row_mask:0xf bank_mask:0xf
    v_add_f32_dpp v88, v89, v88 row_ror:12 row_mask:0xf bank_mask:0xf
    v_add_f32_dpp v90, v91, v90 row_ror:12 row_mask:0xf bank_mask:0xf
    v_add_f32_dpp v92, v93, v92 row_ror:12 row_mask:0xf bank_mask:0xf
    v_add_f32_dpp v94, v95, v94 row_ror:12 row_mask:0xf bank_mask:0xf
    v_add_f32_dpp v96, v97, v96 row_ror:12 row_mask:0xf bank_mask:0xf
    v_add_f32_dpp v98, v99, v98 row_ror:12 row_mask:0xf bank_mask:0xf
    v_add_f32_dpp v100, v101, v100 row_ror:12 row_mask:0xf bank_mask:0xf
    v_add_f32_dpp v102, v103, v102 row_ror:12 row_mask:0xf bank_mask:0xf
    v_add_f32_dpp v104, v105, v104 row_ror:12 row_mask:0xf bank_mask:0xf
    v_add_f32_dpp v106, v107, v106 row_ror:12 row_mask:0xf bank_mask:0xf
    v_add_f32_dpp v108, v109, v108 row_ror:12 row_mask:0xf bank_mask:0xf
    v_add_f32_dpp v110, v111, v110 row_ror:12 row_mask:0xf bank_mask:0xf
    v_add_f32_dpp v112, v113, v112 row_ror:12 row_mask:0xf bank_mask:0xf
    v_add_f32_dpp v114, v115, v114 row_ror:12 row_mask:0xf bank_mask:0xf
    v_add_f32_dpp v24, v86, v84 row_ror:8 row_mask:0xf bank_mask:0xf
    v_add_f32_dpp v25, v90, v88 row_ror:8 row_mask:0xf bank_mask:0xf
    v_add_f32_dpp v26, v94, v92 row_ror:8 row_mask:0xf bank_mask:0xf
    v_add_f32_dpp v27, v98, v96 row_ror:8 row_mask:0xf bank_mask:0xf
    v_add_f32_dpp v28, v102, v100 row_ror:8 row_mask:0xf bank_mask:0xf
    v_add_f32_dpp v29, v106, v104 row_ror:8 row_mask:0xf bank_mask:0xf
    v_add_f32_dpp v30, v110, v108 row_ror:8 row_mask:0xf bank_mask:0xf
    v_add_f32_dpp v31, v114, v112 row_ror:8 row_mask:0xf bank_mask:0xf
    v_cvt_pk_bf16_f32 v32, v24, v25
    v_cvt_pk_bf16_f32 v33, v26, v27
    v_cvt_pk_bf16_f32 v34, v28, v29
    v_cvt_pk_bf16_f32 v35, v30, v31
    v_lshlrev_b32 v24, 16, v32
    v_and_b32 v25, 0xffff0000, v32
    v_lshlrev_b32 v26, 16, v33
    v_and_b32 v27, 0xffff0000, v33
    v_lshlrev_b32 v28, 16, v34
    v_and_b32 v29, 0xffff0000, v34
    v_lshlrev_b32 v30, 16, v35
    v_and_b32 v31, 0xffff0000, v35
    v_mul_f32 v24, s35, v24
    v_mul_f32 v25, s35, v25
    v_mul_f32 v26, s35, v26
    v_mul_f32 v27, s35, v27
    v_mul_f32 v28, s35, v28
    v_mul_f32 v29, s35, v29
    v_mul_f32 v30, s35, v30
    v_mul_f32 v31, s35, v31
    v_cvt_pk_bf16_f32 v32, v24, v25
    v_cvt_pk_bf16_f32 v33, v26, v27
    v_cvt_pk_bf16_f32 v34, v28, v29
    v_cvt_pk_bf16_f32 v35, v30, v31
    ds_write_b128 v251, v[32:35]
    v_add_u32 v251, 1024, v251
    s_waitcnt lgkmcnt(0)
    v_mfma_f32_16x16x32_bf16 v[84:87], v[212:215], v[16:19], 0
    v_mfma_f32_16x16x32_bf16 v[88:91], v[216:219], v[16:19], 0
    v_mfma_f32_16x16x32_bf16 v[92:95], v[220:223], v[16:19], 0
    v_mfma_f32_16x16x32_bf16 v[96:99], v[224:227], v[16:19], 0
    v_mfma_f32_16x16x32_bf16 v[100:103], v[228:231], v[16:19], 0
    v_mfma_f32_16x16x32_bf16 v[104:107], v[232:235], v[16:19], 0
    v_mfma_f32_16x16x32_bf16 v[108:111], v[236:239], v[16:19], 0
    v_mfma_f32_16x16x32_bf16 v[112:115], v[240:243], v[16:19], 0
    s_nop 7
    s_nop 1
    v_add_f32_dpp v84, v85, v84 row_ror:12 row_mask:0xf bank_mask:0xf
    v_add_f32_dpp v86, v87, v86 row_ror:12 row_mask:0xf bank_mask:0xf
    v_add_f32_dpp v88, v89, v88 row_ror:12 row_mask:0xf bank_mask:0xf
    v_add_f32_dpp v90, v91, v90 row_ror:12 row_mask:0xf bank_mask:0xf
    v_add_f32_dpp v92, v93, v92 row_ror:12 row_mask:0xf bank_mask:0xf
    v_add_f32_dpp v94, v95, v94 row_ror:12 row_mask:0xf bank_mask:0xf
    v_add_f32_dpp v96, v97, v96 row_ror:12 row_mask:0xf bank_mask:0xf
    v_add_f32_dpp v98, v99, v98 row_ror:12 row_mask:0xf bank_mask:0xf
    v_add_f32_dpp v100, v101, v100 row_ror:12 row_mask:0xf bank_mask:0xf
    v_add_f32_dpp v102, v103, v102 row_ror:12 row_mask:0xf bank_mask:0xf
    v_add_f32_dpp v104, v105, v104 row_ror:12 row_mask:0xf bank_mask:0xf
    v_add_f32_dpp v106, v107, v106 row_ror:12 row_mask:0xf bank_mask:0xf
    v_add_f32_dpp v108, v109, v108 row_ror:12 row_mask:0xf bank_mask:0xf
    v_add_f32_dpp v110, v111, v110 row_ror:12 row_mask:0xf bank_mask:0xf
    v_add_f32_dpp v112, v113, v112 row_ror:12 row_mask:0xf bank_mask:0xf
    v_add_f32_dpp v114, v115, v114 row_ror:12 row_mask:0xf bank_mask:0xf
    v_add_f32_dpp v24, v86, v84 row_ror:8 row_mask:0xf bank_mask:0xf
    v_add_f32_dpp v25, v90, v88 row_ror:8 row_mask:0xf bank_mask:0xf
    v_add_f32_dpp v26, v94, v92 row_ror:8 row_mask:0xf bank_mask:0xf
    v_add_f32_dpp v27, v98, v96 row_ror:8 row_mask:0xf bank_mask:0xf
    v_add_f32_dpp v28, v102, v100 row_ror:8 row_mask:0xf bank_mask:0xf
    v_add_f32_dpp v29, v106, v104 row_ror:8 row_mask:0xf bank_mask:0xf
    v_add_f32_dpp v30, v110, v108 row_ror:8 row_mask:0xf bank_mask:0xf
    v_add_f32_dpp v31, v114, v112 row_ror:8 row_mask:0xf bank_mask:0xf
    v_cvt_pk_bf16_f32 v32, v24, v25
    v_cvt_pk_bf16_f32 v33, v26, v27
    v_cvt_pk_bf16_f32 v34, v28, v29
    v_cvt_pk_bf16_f32 v35, v30, v31
    v_lshlrev_b32 v24, 16, v32
    v_and_b32 v25, 0xffff0000, v32
    v_lshlrev_b32 v26, 16, v33
    v_and_b32 v27, 0xffff0000, v33
    v_lshlrev_b32 v28, 16, v34
    v_and_b32 v29, 0xffff0000, v34
    v_lshlrev_b32 v30, 16, v35
    v_and_b32 v31, 0xffff0000, v35
    v_mul_f32 v24, s35, v24
    v_mul_f32 v25, s35, v25
    v_mul_f32 v26, s35, v26
    v_mul_f32 v27, s35, v27
    v_mul_f32 v28, s35, v28
    v_mul_f32 v29, s35, v29
    v_mul_f32 v30, s35, v30
    v_mul_f32 v31, s35, v31
    v_cvt_pk_bf16_f32 v32, v24, v25
    v_cvt_pk_bf16_f32 v33, v26, v27
    v_cvt_pk_bf16_f32 v34, v28, v29
    v_cvt_pk_bf16_f32 v35, v30, v31
    ds_write_b128 v251, v[32:35]
    v_add_u32 v251, 1024, v251
L_hk2:
    s_waitcnt lgkmcnt(0)
    ds_write_b32 v246, v247 offset:20768
    s_branch L_hdone
L_hw:
    s_cmp_ge_u32 s3, 4
    s_cbranch_scc1 L_hdone
    ds_write_b32 v246, v247 offset:20736
    s_branch L_loop
L_steady:
    s_setprio 0
    v_mov_b32 v15, v251
    s_waitcnt vmcnt(24)
    v_mfma_f32_16x16x32_bf16 v[84:87], v[116:119], v[16:19], 0
    v_mfma_f32_16x16x32_bf16 v[88:91], v[120:123], v[16:19], 0
    v_mfma_f32_16x16x32_bf16 v[92:95], v[124:127], v[16:19], 0
    v_mfma_f32_16x16x32_bf16 v[96:99], v[128:131], v[16:19], 0
    v_mfma_f32_16x16x32_bf16 v[100:103], v[132:135], v[16:19], 0
    v_mfma_f32_16x16x32_bf16 v[104:107], v[136:139], v[16:19], 0
    v_mfma_f32_16x16x32_bf16 v[108:111], v[140:143], v[16:19], 0
    v_mfma_f32_16x16x32_bf16 v[112:115], v[144:147], v[16:19], 0
    v_readlane_b32 s30, v250, s37
    s_add_u32 s37, s37, 1
    s_and_b32 s28, s30, -2
    s_bitcmp1_b32 s30, 0
    s_cbranch_scc1 L_rv_1
    buffer_load_dwordx4 v[116:119], v2, s[8:11], s28 offen offset:0 nt
    buffer_load_dwordx4 v[120:123], v2, s[8:11], s28 offen offset:1024 nt
    buffer_load_dwordx4 v[124:127], v2, s[8:11], s28 offen offset:2048 nt
    buffer_load_dwordx4 v[128:131], v2, s[8:11], s28 offen offset:3072 nt
    buffer_load_dwordx4 v[132:135], v3, s[8:11], s28 offen offset:0 nt
    buffer_load_dwordx4 v[136:139], v3, s[8:11], s28 offen offset:1024 nt
    buffer_load_dwordx4 v[140:143], v3, s[8:11], s28 offen offset:2048 nt
    buffer_load_dwordx4 v[144:147], v3, s[8:11], s28 offen offset:3072 nt
    s_branch L_rj_2
L_rv_1:
    buffer_load_dwordx4 v[116:119], v4, s[12:15], s28 offen offset:0 nt
    buffer_load_dwordx4 v[120:123], v4, s[12:15], s28 offen offset:1024 nt
    buffer_load_dwordx4 v[124:127], v4, s[12:15], s28 offen offset:2048 nt
    buffer_load_dwordx4 v[128:131], v4, s[12:15], s28 offen offset:3072 nt
    buffer_load_dwordx4 v[132:135], v5, s[12:15], s28 offen offset:0 nt
    buffer_load_dwordx4 v[136:139], v5, s[12:15], s28 offen offset:1024 nt
    buffer_load_dwordx4 v[140:143], v5, s[12:15], s28 offen offset:2048 nt
    buffer_load_dwordx4 v[144:147], v5, s[12:15], s28 offen offset:3072 nt
L_rj_2:
    s_nop 1
    v_add_f32_dpp v84, v85, v84 row_ror:12 row_mask:0xf bank_mask:0xf
    v_add_f32_dpp v86, v87, v86 row_ror:12 row_mask:0xf bank_mask:0xf
    v_add_f32_dpp v88, v89, v88 row_ror:12 row_mask:0xf bank_mask:0xf
    v_add_f32_dpp v90, v91, v90 row_ror:12 row_mask:0xf bank_mask:0xf
    v_add_f32_dpp v92, v93, v92 row_ror:12 row_mask:0xf bank_mask:0xf
    v_add_f32_dpp v94, v95, v94 row_ror:12 row_mask:0xf bank_mask:0xf
    v_add_f32_dpp v96, v97, v96 row_ror:12 row_mask:0xf bank_mask:0xf
    v_add_f32_dpp v98, v99, v98 row_ror:12 row_mask:0xf bank_mask:0xf
    v_add_f32_dpp v100, v101, v100 row_ror:12 row_mask:0xf bank_mask:0xf
    v_add_f32_dpp v102, v103, v102 row_ror:12 row_mask:0xf bank_mask:0xf
    v_add_f32_dpp v104, v105, v104 row_ror:12 row_mask:0xf bank_mask:0xf
    v_add_f32_dpp v106, v107, v106 row_ror:12 row_mask:0xf bank_mask:0xf
    v_add_f32_dpp v108, v109, v108 row_ror:12 row_mask:0xf bank_mask:0xf
    v_add_f32_dpp v110, v111, v110 row_ror:12 row_mask:0xf bank_mask:0xf
    v_add_f32_dpp v112, v113, v112 row_ror:12 row_mask:0xf bank_mask:0xf
    v_add_f32_dpp v114, v115, v114 row_ror:12 row_mask:0xf bank_mask:0xf
    v_add_f32_dpp v24, v86, v84 row_ror:8 row_mask:0xf bank_mask:0xf
    v_add_f32_dpp v25, v90, v88 row_ror:8 row_mask:0xf bank_mask:0xf
    v_add_f32_dpp v26, v94, v92 row_ror:8 row_mask:0xf bank_mask:0xf
    v_add_f32_dpp v27, v98, v96 row_ror:8 row_mask:0xf bank_mask:0xf
    v_add_f32_dpp v28, v102, v100 row_ror:8 row_mask:0xf bank_mask:0xf
    v_add_f32_dpp v29, v106, v104 row_ror:8 row_mask:0xf bank_mask:0xf
    v_add_f32_dpp v30, v110, v108 row_ror:8 row_mask:0xf bank_mask:0xf
    v_add_f32_dpp v31, v114, v112 row_ror:8 row_mask:0xf bank_mask:0xf
    v_cvt_pk_bf16_f32 v32, v24, v25
    v_cvt_pk_bf16_f32 v33, v26, v27
    v_cvt_pk_bf16_f32 v34, v28, v29
    v_cvt_pk_bf16_f32 v35, v30, v31
    v_lshlrev_b32 v24, 16, v32
    v_and_b32 v25, 0xffff0000, v32
    v_lshlrev_b32 v26, 16, v33
    v_and_b32 v27, 0xffff0000, v33
    v_lshlrev_b32 v28, 16, v34
    v_and_b32 v29, 0xffff0000, v34
    v_lshlrev_b32 v30, 16, v35
    v_and_b32 v31, 0xffff0000, v35
    v_mul_f32 v24, s35, v24
    v_mul_f32 v25, s35, v25
    v_mul_f32 v26, s35, v26
    v_mul_f32 v27, s35, v27
    v_mul_f32 v28, s35, v28
    v_mul_f32 v29, s35, v29
    v_mul_f32 v30, s35, v30
    v_mul_f32 v31, s35, v31
    v_cvt_pk_bf16_f32 v32, v24, v25
    v_cvt_pk_bf16_f32 v33, v26, v27
    v_cvt_pk_bf16_f32 v34, v28, v29
    v_cvt_pk_bf16_f32 v35, v30, v31
    ds_write_b128 v251, v[32:35]
    v_add_u32 v251, 1024, v251
    s_waitcnt vmcnt(24)
    v_mfma_f32_16x16x32_bf16 v[84:87], v[148:151], v[16:19], 0
    v_mfma_f32_16x16x32_bf16 v[88:91], v[152:155], v[16:19], 0
    v_mfma_f32_16x16x32_bf16 v[92:95], v[156:159], v[16:19], 0
    v_mfma_f32_16x16x32_bf16 v[96:99], v[160:163], v[16:19], 0
    v_mfma_f32_16x16x32_bf16 v[100:103], v[164:167], v[16:19], 0
    v_mfma_f32_16x16x32_bf16 v[104:107], v[168:171], v[16:19], 0
    v_mfma_f32_16x16x32_bf16 v[108:111], v[172:175], v[16:19], 0
    v_mfma_f32_16x16x32_bf16 v[112:115], v[176:179], v[16:19], 0
    v_readlane_b32 s30, v250, s37
    s_add_u32 s37, s37, 1
    s_and_b32 s28, s30, -2
    s_bitcmp1_b32 s30, 0
    s_cbranch_scc1 L_rv_3
    buffer_load_dwordx4 v[148:151], v2, s[8:11], s28 offen offset:0 nt
    buffer_load_dwordx4 v[152:155], v2, s[8:11], s28 offen offset:1024 nt
    buffer_load_dwordx4 v[156:159], v2, s[8:11], s28 offen offset:2048 nt
    buffer_load_dwordx4 v[160:163], v2, s[8:11], s28 offen offset:3072 nt
    buffer_load_dwordx4 v[164:167], v3, s[8:11], s28 offen offset:0 nt
    buffer_load_dwordx4 v[168:171], v3, s[8:11], s28 offen offset:1024 nt
    buffer_load_dwordx4 v[172:175], v3, s[8:11], s28 offen offset:2048 nt
    buffer_load_dwordx4 v[176:179], v3, s[8:11], s28 offen offset:3072 nt
    s_branch L_rj_4
L_rv_3:
    buffer_load_dwordx4 v[148:151], v4, s[12:15], s28 offen offset:0 nt
    buffer_load_dwordx4 v[152:155], v4, s[12:15], s28 offen offset:1024 nt
    buffer_load_dwordx4 v[156:159], v4, s[12:15], s28 offen offset:2048 nt
    buffer_load_dwordx4 v[160:163], v4, s[12:15], s28 offen offset:3072 nt
    buffer_load_dwordx4 v[164:167], v5, s[12:15], s28 offen offset:0 nt
    buffer_load_dwordx4 v[168:171], v5, s[12:15], s28 offen offset:1024 nt
    buffer_load_dwordx4 v[172:175], v5, s[12:15], s28 offen offset:2048 nt
    buffer_load_dwordx4 v[176:179], v5, s[12:15], s28 offen offset:3072 nt
L_rj_4:
    s_nop 1
    v_add_f32_dpp v84, v85, v84 row_ror:12 row_mask:0xf bank_mask:0xf
    v_add_f32_dpp v86, v87, v86 row_ror:12 row_mask:0xf bank_mask:0xf
    v_add_f32_dpp v88, v89, v88 row_ror:12 row_mask:0xf bank_mask:0xf
    v_add_f32_dpp v90, v91, v90 row_ror:12 row_mask:0xf bank_mask:0xf
    v_add_f32_dpp v92, v93, v92 row_ror:12 row_mask:0xf bank_mask:0xf
    v_add_f32_dpp v94, v95, v94 row_ror:12 row_mask:0xf bank_mask:0xf
    v_add_f32_dpp v96, v97, v96 row_ror:12 row_mask:0xf bank_mask:0xf
    v_add_f32_dpp v98, v99, v98 row_ror:12 row_mask:0xf bank_mask:0xf
    v_add_f32_dpp v100, v101, v100 row_ror:12 row_mask:0xf bank_mask:0xf
    v_add_f32_dpp v102, v103, v102 row_ror:12 row_mask:0xf bank_mask:0xf
    v_add_f32_dpp v104, v105, v104 row_ror:12 row_mask:0xf bank_mask:0xf
    v_add_f32_dpp v106, v107, v106 row_ror:12 row_mask:0xf bank_mask:0xf
    v_add_f32_dpp v108, v109, v108 row_ror:12 row_mask:0xf bank_mask:0xf
    v_add_f32_dpp v110, v111, v110 row_ror:12 row_mask:0xf bank_mask:0xf
    v_add_f32_dpp v112, v113, v112 row_ror:12 row_mask:0xf bank_mask:0xf
    v_add_f32_dpp v114, v115, v114 row_ror:12 row_mask:0xf bank_mask:0xf
    v_add_f32_dpp v24, v86, v84 row_ror:8 row_mask:0xf bank_mask:0xf
    v_add_f32_dpp v25, v90, v88 row_ror:8 row_mask:0xf bank_mask:0xf
    v_add_f32_dpp v26, v94, v92 row_ror:8 row_mask:0xf bank_mask:0xf
    v_add_f32_dpp v27, v98, v96 row_ror:8 row_mask:0xf bank_mask:0xf
    v_add_f32_dpp v28, v102, v100 row_ror:8 row_mask:0xf bank_mask:0xf
    v_add_f32_dpp v29, v106, v104 row_ror:8 row_mask:0xf bank_mask:0xf
    v_add_f32_dpp v30, v110, v108 row_ror:8 row_mask:0xf bank_mask:0xf
    v_add_f32_dpp v31, v114, v112 row_ror:8 row_mask:0xf bank_mask:0xf
    v_cvt_pk_bf16_f32 v32, v24, v25
    v_cvt_pk_bf16_f32 v33, v26, v27
    v_cvt_pk_bf16_f32 v34, v28, v29
    v_cvt_pk_bf16_f32 v35, v30, v31
    v_lshlrev_b32 v24, 16, v32
    v_and_b32 v25, 0xffff0000, v32
    v_lshlrev_b32 v26, 16, v33
    v_and_b32 v27, 0xffff0000, v33
    v_lshlrev_b32 v28, 16, v34
    v_and_b32 v29, 0xffff0000, v34
    v_lshlrev_b32 v30, 16, v35
    v_and_b32 v31, 0xffff0000, v35
    v_mul_f32 v24, s35, v24
    v_mul_f32 v25, s35, v25
    v_mul_f32 v26, s35, v26
    v_mul_f32 v27, s35, v27
    v_mul_f32 v28, s35, v28
    v_mul_f32 v29, s35, v29
    v_mul_f32 v30, s35, v30
    v_mul_f32 v31, s35, v31
    v_cvt_pk_bf16_f32 v32, v24, v25
    v_cvt_pk_bf16_f32 v33, v26, v27
    v_cvt_pk_bf16_f32 v34, v28, v29
    v_cvt_pk_bf16_f32 v35, v30, v31
    ds_write_b128 v251, v[32:35]
    v_add_u32 v251, 1024, v251
    s_waitcnt vmcnt(24)
    v_mfma_f32_16x16x32_bf16 v[84:87], v[180:183], v[16:19], 0
    v_mfma_f32_16x16x32_bf16 v[88:91], v[184:187], v[16:19], 0
    v_mfma_f32_16x16x32_bf16 v[92:95], v[188:191], v[16:19], 0
    v_mfma_f32_16x16x32_bf16 v[96:99], v[192:195], v[16:19], 0
    v_mfma_f32_16x16x32_bf16 v[100:103], v[196:199], v[16:19], 0
    v_mfma_f32_16x16x32_bf16 v[104:107], v[200:203], v[16:19], 0
    v_mfma_f32_16x16x32_bf16 v[108:111], v[204:207], v[16:19], 0
    v_mfma_f32_16x16x32_bf16 v[112:115], v[208:211], v[16:19], 0
    s_nop 7
    s_nop 1
    v_add_f32_dpp v84, v85, v84 row_ror:12 row_mask:0xf bank_mask:0xf
    v_add_f32_dpp v86, v87, v86 row_ror:12 row_mask:0xf bank_mask:0xf
    v_add_f32_dpp v88, v89, v88 row_ror:12 row_mask:0xf bank_mask:0xf
    v_add_f32_dpp v90, v91, v90 row_ror:12 row_mask:0xf bank_mask:0xf
    v_add_f32_dpp v92, v93, v92 row_ror:12 row_mask:0xf bank_mask:0xf
    v_add_f32_dpp v94, v95, v94 row_ror:12 row_mask:0xf bank_mask:0xf
    v_add_f32_dpp v96, v97, v96 row_ror:12 row_mask:0xf bank_mask:0xf
    v_add_f32_dpp v98, v99, v98 row_ror:12 row_mask:0xf bank_mask:0xf
    v_add_f32_dpp v100, v101, v100 row_ror:12 row_mask:0xf bank_mask:0xf
    v_add_f32_dpp v102, v103, v102 row_ror:12 row_mask:0xf bank_mask:0xf
    v_add_f32_dpp v104, v105, v104 row_ror:12 row_mask:0xf bank_mask:0xf
    v_add_f32_dpp v106, v107, v106 row_ror:12 row_mask:0xf bank_mask:0xf
    v_add_f32_dpp v108, v109, v108 row_ror:12 row_mask:0xf bank_mask:0xf
    v_add_f32_dpp v110, v111, v110 row_ror:12 row_mask:0xf bank_mask:0xf
    v_add_f32_dpp v112, v113, v112 row_ror:12 row_mask:0xf bank_mask:0xf
    v_add_f32_dpp v114, v115, v114 row_ror:12 row_mask:0xf bank_mask:0xf
    v_add_f32_dpp v24, v86, v84 row_ror:8 row_mask:0xf bank_mask:0xf
    v_add_f32_dpp v25, v90, v88 row_ror:8 row_mask:0xf bank_mask:0xf
    v_add_f32_dpp v26, v94, v92 row_ror:8 row_mask:0xf bank_mask:0xf
    v_add_f32_dpp v27, v98, v96 row_ror:8 row_mask:0xf bank_mask:0xf
    v_add_f32_dpp v28, v102, v100 row_ror:8 row_mask:0xf bank_mask:0xf
    v_add_f32_dpp v29, v106, v104 row_ror:8 row_mask:0xf bank_mask:0xf
    v_add_f32_dpp v30, v110, v108 row_ror:8 row_mask:0xf bank_mask:0xf
    v_add_f32_dpp v31, v114, v112 row_ror:8 row_mask:0xf bank_mask:0xf
    v_cvt_pk_bf16_f32 v32, v24, v25
    v_cvt_pk_bf16_f32 v33, v26, v27
    v_cvt_pk_bf16_f32 v34, v28, v29
    v_cvt_pk_bf16_f32 v35, v30, v31
    v_lshlrev_b32 v24, 16, v32
    v_and_b32 v25, 0xffff0000, v32
    v_lshlrev_b32 v26, 16, v33
    v_and_b32 v27, 0xffff0000, v33
    v_lshlrev_b32 v28, 16, v34
    v_and_b32 v29, 0xffff0000, v34
    v_lshlrev_b32 v30, 16, v35
    v_and_b32 v31, 0xffff0000, v35
    v_mul_f32 v24, s35, v24
    v_mul_f32 v25, s35, v25
    v_mul_f32 v26, s35, v26
    v_mul_f32 v27, s35, v27
    v_mul_f32 v28, s35, v28
    v_mul_f32 v29, s35, v29
    v_mul_f32 v30, s35, v30
    v_mul_f32 v31, s35, v31
    v_cvt_pk_bf16_f32 v32, v24, v25
    v_cvt_pk_bf16_f32 v33, v26, v27
    v_cvt_pk_bf16_f32 v34, v28, v29
    v_cvt_pk_bf16_f32 v35, v30, v31
    ds_write_b128 v251, v[32:35]
    v_add_u32 v251, 1024, v251
    s_waitcnt vmcnt(16)
    v_mfma_f32_16x16x32_bf16 v[84:87], v[212:215], v[16:19], 0
    v_mfma_f32_16x16x32_bf16 v[88:91], v[216:219], v[16:19], 0
    v_mfma_f32_16x16x32_bf16 v[92:95], v[220:223], v[16:19], 0
    v_mfma_f32_16x16x32_bf16 v[96:99], v[224:227], v[16:19], 0
    v_mfma_f32_16x16x32_bf16 v[100:103], v[228:231], v[16:19], 0
    v_mfma_f32_16x16x32_bf16 v[104:107], v[232:235], v[16:19], 0
    v_mfma_f32_16x16x32_bf16 v[108:111], v[236:239], v[16:19], 0
    v_mfma_f32_16x16x32_bf16 v[112:115], v[240:243], v[16:19], 0
    s_nop 7
    s_nop 1
    v_add_f32_dpp v84, v85, v84 row_ror:12 row_mask:0xf bank_mask:0xf
    v_add_f32_dpp v86, v87, v86 row_ror:12 row_mask:0xf bank_mask:0xf
    v_add_f32_dpp v88, v89, v88 row_ror:12 row_mask:0xf bank_mask:0xf
    v_add_f32_dpp v90, v91, v90 row_ror:12 row_mask:0xf bank_mask:0xf
    v_add_f32_dpp v92, v93, v92 row_ror:12 row_mask:0xf bank_mask:0xf
    v_add_f32_dpp v94, v95, v94 row_ror:12 row_mask:0xf bank_mask:0xf
    v_add_f32_dpp v96, v97, v96 row_ror:12 row_mask:0xf bank_mask:0xf
    v_add_f32_dpp v98, v99, v98 row_ror:12 row_mask:0xf bank_mask:0xf
    v_add_f32_dpp v100, v101, v100 row_ror:12 row_mask:0xf bank_mask:0xf
    v_add_f32_dpp v102, v103, v102 row_ror:12 row_mask:0xf bank_mask:0xf
    v_add_f32_dpp v104, v105, v104 row_ror:12 row_mask:0xf bank_mask:0xf
    v_add_f32_dpp v106, v107, v106 row_ror:12 row_mask:0xf bank_mask:0xf
    v_add_f32_dpp v108, v109, v108 row_ror:12 row_mask:0xf bank_mask:0xf
    v_add_f32_dpp v110, v111, v110 row_ror:12 row_mask:0xf bank_mask:0xf
    v_add_f32_dpp v112, v113, v112 row_ror:12 row_mask:0xf bank_mask:0xf
    v_add_f32_dpp v114, v115, v114 row_ror:12 row_mask:0xf bank_mask:0xf
    v_add_f32_dpp v24, v86, v84 row_ror:8 row_mask:0xf bank_mask:0xf
    v_add_f32_dpp v25, v90, v88 row_ror:8 row_mask:0xf bank_mask:0xf
    v_add_f32_dpp v26, v94, v92 row_ror:8 row_mask:0xf bank_mask:0xf
    v_add_f32_dpp v27, v98, v96 row_ror:8 row_mask:0xf bank_mask:0xf
    v_add_f32_dpp v28, v102, v100 row_ror:8 row_mask:0xf bank_mask:0xf
    v_add_f32_dpp v29, v106, v104 row_ror:8 row_mask:0xf bank_mask:0xf
    v_add_f32_dpp v30, v110, v108 row_ror:8 row_mask:0xf bank_mask:0xf
    v_add_f32_dpp v31, v114, v112 row_ror:8 row_mask:0xf bank_mask:0xf
    v_cvt_pk_bf16_f32 v32, v24, v25
    v_cvt_pk_bf16_f32 v33, v26, v27
    v_cvt_pk_bf16_f32 v34, v28, v29
    v_cvt_pk_bf16_f32 v35, v30, v31
    v_lshlrev_b32 v24, 16, v32
    v_and_b32 v25, 0xffff0000, v32
    v_lshlrev_b32 v26, 16, v33
    v_and_b32 v27, 0xffff0000, v33
    v_lshlrev_b32 v28, 16, v34
    v_and_b32 v29, 0xffff0000, v34
    v_lshlrev_b32 v30, 16, v35
    v_and_b32 v31, 0xffff0000, v35
    v_mul_f32 v24, s35, v24
    v_mul_f32 v25, s35, v25
    v_mul_f32 v26, s35, v26
    v_mul_f32 v27, s35, v27
    v_mul_f32 v28, s35, v28
    v_mul_f32 v29, s35, v29
    v_mul_f32 v30, s35, v30
    v_mul_f32 v31, s35, v31
    v_cvt_pk_bf16_f32 v32, v24, v25
    v_cvt_pk_bf16_f32 v33, v26, v27
    v_cvt_pk_bf16_f32 v34, v28, v29
    v_cvt_pk_bf16_f32 v35, v30, v31
    ds_write_b128 v251, v[32:35]
    v_add_u32 v251, 1024, v251
L_ka:
    s_waitcnt vmcnt(8)
    v_mfma_f32_16x16x32_bf16 v[84:87], v[116:119], v[16:19], 0
    v_mfma_f32_16x16x32_bf16 v[88:91], v[120:123], v[16:19], 0
    v_mfma_f32_16x16x32_bf16 v[92:95], v[124:127], v[16:19], 0
    v_mfma_f32_16x16x32_bf16 v[96:99], v[128:131], v[16:19], 0
    v_mfma_f32_16x16x32_bf16 v[100:103], v[132:135], v[16:19], 0
    v_mfma_f32_16x16x32_bf16 v[104:107], v[136:139], v[16:19], 0
    v_mfma_f32_16x16x32_bf16 v[108:111], v[140:143], v[16:19], 0
    v_mfma_f32_16x16x32_bf16 v[112:115], v[144:147], v[16:19], 0
    v_readlane_b32 s30, v250, s37
    s_add_u32 s37, s37, 1
    s_and_b32 s28, s30, -2
    s_bitcmp1_b32 s30, 0
    s_cbranch_scc1 L_rv_5
    buffer_load_dwordx4 v[116:119], v2, s[8:11], s28 offen offset:0 nt
    buffer_load_dwordx4 v[120:123], v2, s[8:11], s28 offen offset:1024 nt
    buffer_load_dwordx4 v[124:127], v2, s[8:11], s28 offen offset:2048 nt
    buffer_load_dwordx4 v[128:131], v2, s[8:11], s28 offen offset:3072 nt
    buffer_load_dwordx4 v[132:135], v3, s[8:11], s28 offen offset:0 nt
    buffer_load_dwordx4 v[136:139], v3, s[8:11], s28 offen offset:1024 nt
    buffer_load_dwordx4 v[140:143], v3, s[8:11], s28 offen offset:2048 nt
    buffer_load_dwordx4 v[144:147], v3, s[8:11], s28 offen offset:3072 nt
    s_branch L_rj_6
L_rv_5:
    buffer_load_dwordx4 v[116:119], v4, s[12:15], s28 offen offset:0 nt
    buffer_load_dwordx4 v[120:123], v4, s[12:15], s28 offen offset:1024 nt
    buffer_load_dwordx4 v[124:127], v4, s[12:15], s28 offen offset:2048 nt
    buffer_load_dwordx4 v[128:131], v4, s[12:15], s28 offen offset:3072 nt
    buffer_load_dwordx4 v[132:135], v5, s[12:15], s28 offen offset:0 nt
    buffer_load_dwordx4 v[136:139], v5, s[12:15], s28 offen offset:1024 nt
    buffer_load_dwordx4 v[140:143], v5, s[12:15], s28 offen offset:2048 nt
    buffer_load_dwordx4 v[144:147], v5, s[12:15], s28 offen offset:3072 nt
L_rj_6:
    s_nop 1
    v_add_f32_dpp v84, v85, v84 row_ror:12 row_mask:0xf bank_mask:0xf
    v_add_f32_dpp v86, v87, v86 row_ror:12 row_mask:0xf bank_mask:0xf
    v_add_f32_dpp v88, v89, v88 row_ror:12 row_mask:0xf bank_mask:0xf
    v_add_f32_dpp v90, v91, v90 row_ror:12 row_mask:0xf bank_mask:0xf
    v_add_f32_dpp v92, v93, v92 row_ror:12 row_mask:0xf bank_mask:0xf
    v_add_f32_dpp v94, v95, v94 row_ror:12 row_mask:0xf bank_mask:0xf
    v_add_f32_dpp v96, v97, v96 row_ror:12 row_mask:0xf bank_mask:0xf
    v_add_f32_dpp v98, v99, v98 row_ror:12 row_mask:0xf bank_mask:0xf
    v_add_f32_dpp v100, v101, v100 row_ror:12 row_mask:0xf bank_mask:0xf
    v_add_f32_dpp v102, v103, v102 row_ror:12 row_mask:0xf bank_mask:0xf
    v_add_f32_dpp v104, v105, v104 row_ror:12 row_mask:0xf bank_mask:0xf
    v_add_f32_dpp v106, v107, v106 row_ror:12 row_mask:0xf bank_mask:0xf
    v_add_f32_dpp v108, v109, v108 row_ror:12 row_mask:0xf bank_mask:0xf
    v_add_f32_dpp v110, v111, v110 row_ror:12 row_mask:0xf bank_mask:0xf
    v_add_f32_dpp v112, v113, v112 row_ror:12 row_mask:0xf bank_mask:0xf
    v_add_f32_dpp v114, v115, v114 row_ror:12 row_mask:0xf bank_mask:0xf
    v_add_f32_dpp v24, v86, v84 row_ror:8 row_mask:0xf bank_mask:0xf
    v_add_f32_dpp v25, v90, v88 row_ror:8 row_mask:0xf bank_mask:0xf
    v_add_f32_dpp v26, v94, v92 row_ror:8 row_mask:0xf bank_mask:0xf
    v_add_f32_dpp v27, v98, v96 row_ror:8 row_mask:0xf bank_mask:0xf
    v_add_f32_dpp v28, v102, v100 row_ror:8 row_mask:0xf bank_mask:0xf
    v_add_f32_dpp v29, v106, v104 row_ror:8 row_mask:0xf bank_mask:0xf
    v_add_f32_dpp v30, v110, v108 row_ror:8 row_mask:0xf bank_mask:0xf
    v_add_f32_dpp v31, v114, v112 row_ror:8 row_mask:0xf bank_mask:0xf
    v_cvt_pk_bf16_f32 v32, v24, v25
    v_cvt_pk_bf16_f32 v33, v26, v27
    v_cvt_pk_bf16_f32 v34, v28, v29
    v_cvt_pk_bf16_f32 v35, v30, v31
    v_lshlrev_b32 v24, 16, v32
    v_and_b32 v25, 0xffff0000, v32
    v_lshlrev_b32 v26, 16, v33
    v_and_b32 v27, 0xffff0000, v33
    v_lshlrev_b32 v28, 16, v34
    v_and_b32 v29, 0xffff0000, v34
    v_lshlrev_b32 v30, 16, v35
    v_and_b32 v31, 0xffff0000, v35
    v_mul_f32 v24, s35, v24
    v_mul_f32 v25, s35, v25
    v_mul_f32 v26, s35, v26
    v_mul_f32 v27, s35, v27
    v_mul_f32 v28, s35, v28
    v_mul_f32 v29, s35, v29
    v_mul_f32 v30, s35, v30
    v_mul_f32 v31, s35, v31
    v_cvt_pk_bf16_f32 v32, v24, v25
    v_cvt_pk_bf16_f32 v33, v26, v27
    v_cvt_pk_bf16_f32 v34, v28, v29
    v_cvt_pk_bf16_f32 v35, v30, v31
    ds_write_b128 v251, v[32:35]
    v_add_u32 v251, 1024, v251
    s_sub_u32 s48, s48, 1
    s_cmp_eq_u32 s48, 0
    s_cbranch_scc1 L_vb0
    s_waitcnt vmcnt(8)
    v_mfma_f32_16x16x32_bf16 v[84:87], v[148:151], v[16:19], 0
    v_mfma_f32_16x16x32_bf16 v[88:91], v[152:155], v[16:19], 0
    v_mfma_f32_16x16x32_bf16 v[92:95], v[156:159], v[16:19], 0
    v_mfma_f32_16x16x32_bf16 v[96:99], v[160:163], v[16:19], 0
    v_mfma_f32_16x16x32_bf16 v[100:103], v[164:167], v[16:19], 0
    v_mfma_f32_16x16x32_bf16 v[104:107], v[168:171], v[16:19], 0
    v_mfma_f32_16x16x32_bf16 v[108:111], v[172:175], v[16:19], 0
    v_mfma_f32_16x16x32_bf16 v[112:115], v[176:179], v[16:19], 0
    v_readlane_b32 s30, v250, s37
    s_add_u32 s37, s37, 1
    s_and_b32 s28, s30, -2
    s_bitcmp1_b32 s30, 0
    s_cbranch_scc1 L_rv_7
    buffer_load_dwordx4 v[148:151], v2, s[8:11], s28 offen offset:0 nt
    buffer_load_dwordx4 v[152:155], v2, s[8:11], s28 offen offset:1024 nt
    buffer_load_dwordx4 v[156:159], v2, s[8:11], s28 offen offset:2048 nt
    buffer_load_dwordx4 v[160:163], v2, s[8:11], s28 offen offset:3072 nt
    buffer_load_dwordx4 v[164:167], v3, s[8:11], s28 offen offset:0 nt
    buffer_load_dwordx4 v[168:171], v3, s[8:11], s28 offen offset:1024 nt
    buffer_load_dwordx4 v[172:175], v3, s[8:11], s28 offen offset:2048 nt
    buffer_load_dwordx4 v[176:179], v3, s[8:11], s28 offen offset:3072 nt
    s_branch L_rj_8
L_rv_7:
    buffer_load_dwordx4 v[148:151], v4, s[12:15], s28 offen offset:0 nt
    buffer_load_dwordx4 v[152:155], v4, s[12:15], s28 offen offset:1024 nt
    buffer_load_dwordx4 v[156:159], v4, s[12:15], s28 offen offset:2048 nt
    buffer_load_dwordx4 v[160:163], v4, s[12:15], s28 offen offset:3072 nt
    buffer_load_dwordx4 v[164:167], v5, s[12:15], s28 offen offset:0 nt
    buffer_load_dwordx4 v[168:171], v5, s[12:15], s28 offen offset:1024 nt
    buffer_load_dwordx4 v[172:175], v5, s[12:15], s28 offen offset:2048 nt
    buffer_load_dwordx4 v[176:179], v5, s[12:15], s28 offen offset:3072 nt
L_rj_8:
    s_nop 1
    v_add_f32_dpp v84, v85, v84 row_ror:12 row_mask:0xf bank_mask:0xf
    v_add_f32_dpp v86, v87, v86 row_ror:12 row_mask:0xf bank_mask:0xf
    v_add_f32_dpp v88, v89, v88 row_ror:12 row_mask:0xf bank_mask:0xf
    v_add_f32_dpp v90, v91, v90 row_ror:12 row_mask:0xf bank_mask:0xf
    v_add_f32_dpp v92, v93, v92 row_ror:12 row_mask:0xf bank_mask:0xf
    v_add_f32_dpp v94, v95, v94 row_ror:12 row_mask:0xf bank_mask:0xf
    v_add_f32_dpp v96, v97, v96 row_ror:12 row_mask:0xf bank_mask:0xf
    v_add_f32_dpp v98, v99, v98 row_ror:12 row_mask:0xf bank_mask:0xf
    v_add_f32_dpp v100, v101, v100 row_ror:12 row_mask:0xf bank_mask:0xf
    v_add_f32_dpp v102, v103, v102 row_ror:12 row_mask:0xf bank_mask:0xf
    v_add_f32_dpp v104, v105, v104 row_ror:12 row_mask:0xf bank_mask:0xf
    v_add_f32_dpp v106, v107, v106 row_ror:12 row_mask:0xf bank_mask:0xf
    v_add_f32_dpp v108, v109, v108 row_ror:12 row_mask:0xf bank_mask:0xf
    v_add_f32_dpp v110, v111, v110 row_ror:12 row_mask:0xf bank_mask:0xf
    v_add_f32_dpp v112, v113, v112 row_ror:12 row_mask:0xf bank_mask:0xf
    v_add_f32_dpp v114, v115, v114 row_ror:12 row_mask:0xf bank_mask:0xf
    v_add_f32_dpp v24, v86, v84 row_ror:8 row_mask:0xf bank_mask:0xf
    v_add_f32_dpp v25, v90, v88 row_ror:8 row_mask:0xf bank_mask:0xf
    v_add_f32_dpp v26, v94, v92 row_ror:8 row_mask:0xf bank_mask:0xf
    v_add_f32_dpp v27, v98, v96 row_ror:8 row_mask:0xf bank_mask:0xf
    v_add_f32_dpp v28, v102, v100 row_ror:8 row_mask:0xf bank_mask:0xf
    v_add_f32_dpp v29, v106, v104 row_ror:8 row_mask:0xf bank_mask:0xf
    v_add_f32_dpp v30, v110, v108 row_ror:8 row_mask:0xf bank_mask:0xf
    v_add_f32_dpp v31, v114, v112 row_ror:8 row_mask:0xf bank_mask:0xf
    v_cvt_pk_bf16_f32 v32, v24, v25
    v_cvt_pk_bf16_f32 v33, v26, v27
    v_cvt_pk_bf16_f32 v34, v28, v29
    v_cvt_pk_bf16_f32 v35, v30, v31
    v_lshlrev_b32 v24, 16, v32
    v_and_b32 v25, 0xffff0000, v32
    v_lshlrev_b32 v26, 16, v33
    v_and_b32 v27, 0xffff0000, v33
    v_lshlrev_b32 v28, 16, v34
    v_and_b32 v29, 0xffff0000, v34
    v_lshlrev_b32 v30, 16, v35
    v_and_b32 v31, 0xffff0000, v35
    v_mul_f32 v24, s35, v24
    v_mul_f32 v25, s35, v25
    v_mul_f32 v26, s35, v26
    v_mul_f32 v27, s35, v27
    v_mul_f32 v28, s35, v28
    v_mul_f32 v29, s35, v29
    v_mul_f32 v30, s35, v30
    v_mul_f32 v31, s35, v31
    v_cvt_pk_bf16_f32 v32, v24, v25
    v_cvt_pk_bf16_f32 v33, v26, v27
    v_cvt_pk_bf16_f32 v34, v28, v29
    v_cvt_pk_bf16_f32 v35, v30, v31
    ds_write_b128 v251, v[32:35]
    v_add_u32 v251, 1024, v251
    s_sub_u32 s48, s48, 1
    s_cmp_lg_u32 s48, 0
    s_cbranch_scc1 L_ka
L_va:
    s_cmp_lg_u32 s49, s50
    s_cbranch_scc1 L_va1
L_vchk:
    ds_read_b32 v13, v246 offset:20768
    s_waitcnt lgkmcnt(0)
    v_readfirstlane_b32 s30, v13
    s_cmp_eq_u32 s30, -1
    s_cbranch_scc1 L_va1
    s_sleep 1
    s_sub_u32 s40, s40, 1
    s_cmp_lg_u32 s40, 0
    s_cbranch_scc1 L_vchk
    s_mov_b32 s40, 65536
L_va1:
    ds_read_b128 v[32:35], v15
    v_add_u32 v15, 1024, v15
    s_waitcnt lgkmcnt(0)
    v_lshlrev_b32 v24, 16, v32
    v_and_b32 v25, 0xffff0000, v32
    v_lshlrev_b32 v26, 16, v33
    v_and_b32 v27, 0xffff0000, v33
    v_lshlrev_b32 v28, 16, v34
    v_and_b32 v29, 0xffff0000, v34
    v_lshlrev_b32 v30, 16, v35
    v_and_b32 v31, 0xffff0000, v35
    v_max3_f32 v10, v24, v25, v26
    v_max3_f32 v11, v27, v28, v29
    v_max3_f32 v10, v10, v30, v31
    v_max3_f32 v10, v10, v11, v6
    v_mov_b32 v11, v10
    s_nop 1
    v_permlane32_swap_b32 v10, v11
    v_max_f32 v10, v10, v11
    v_mov_b32 v11, v10
    s_nop 1
    v_permlane16_swap_b32 v10, v11
    v_max_f32 v10, v10, v11
    v_sub_f32 v8, v6, v10
    v_mul_f32 v9, s34, v10
    v_mul_f32 v8, s34, v8
    v_mov_b32 v6, v10
    v_exp_f32 v8, v8
    v_fma_f32 v24, v24, s34, -v9
    v_fma_f32 v25, v25, s34, -v9
    v_fma_f32 v26, v26, s34, -v9
    v_fma_f32 v27, v27, s34, -v9
    v_fma_f32 v28, v28, s34, -v9
    v_fma_f32 v29, v29, s34, -v9
    v_fma_f32 v30, v30, s34, -v9
    v_fma_f32 v31, v31, s34, -v9
    v_exp_f32 v24, v24
    v_exp_f32 v25, v25
    v_exp_f32 v26, v26
    v_exp_f32 v27, v27
    v_exp_f32 v28, v28
    v_exp_f32 v29, v29
    v_exp_f32 v30, v30
    v_exp_f32 v31, v31
    v_pk_mul_f32 v[52:53], v[52:53], v[8:9] op_sel_hi:[1,0]
    v_pk_mul_f32 v[54:55], v[54:55], v[8:9] op_sel_hi:[1,0]
    v_pk_mul_f32 v[56:57], v[56:57], v[8:9] op_sel_hi:[1,0]
    v_pk_mul_f32 v[58:59], v[58:59], v[8:9] op_sel_hi:[1,0]
    v_pk_mul_f32 v[60:61], v[60:61], v[8:9] op_sel_hi:[1,0]
    v_pk_mul_f32 v[62:63], v[62:63], v[8:9] op_sel_hi:[1,0]
    v_pk_mul_f32 v[64:65], v[64:65], v[8:9] op_sel_hi:[1,0]
    v_pk_mul_f32 v[66:67], v[66:67], v[8:9] op_sel_hi:[1,0]
    v_pk_mul_f32 v[68:69], v[68:69], v[8:9] op_sel_hi:[1,0]
    v_pk_mul_f32 v[70:71], v[70:71], v[8:9] op_sel_hi:[1,0]
    v_pk_mul_f32 v[72:73], v[72:73], v[8:9] op_sel_hi:[1,0]
    v_pk_mul_f32 v[74:75], v[74:75], v[8:9] op_sel_hi:[1,0]
    v_pk_mul_f32 v[76:77], v[76:77], v[8:9] op_sel_hi:[1,0]
    v_pk_mul_f32 v[78:79], v[78:79], v[8:9] op_sel_hi:[1,0]
    v_pk_mul_f32 v[80:81], v[80:81], v[8:9] op_sel_hi:[1,0]
    v_pk_mul_f32 v[82:83], v[82:83], v[8:9] op_sel_hi:[1,0]
    v_cvt_pk_bf16_f32 v20, v24, v25
    v_cvt_pk_bf16_f32 v21, v26, v27
    v_cvt_pk_bf16_f32 v22, v28, v29
    v_cvt_pk_bf16_f32 v23, v30, v31
    v_add_f32 v10, v24, v25
    v_add_f32 v11, v26, v27
    v_add_f32 v28, v28, v29
    v_add_f32 v30, v30, v31
    v_add_f32 v10, v10, v11
    v_add_f32 v28, v28, v30
    v_add_f32 v10, v10, v28
    v_fma_f32 v7, v7, v8, v10
    s_waitcnt vmcnt(8)
    v_perm_b32 v84, v120, v116, s32
    v_perm_b32 v85, v128, v124, s32
    v_perm_b32 v86, v136, v132, s32
    v_perm_b32 v87, v144, v140, s32
    v_perm_b32 v88, v120, v116, s33
    v_perm_b32 v89, v128, v124, s33
    v_perm_b32 v90, v136, v132, s33
    v_perm_b32 v91, v144, v140, s33
    v_mfma_f32_16x16x32_bf16 v[52:55], v[84:87], v[20:23], v[52:55]
    v_perm_b32 v92, v121, v117, s32
    v_perm_b32 v93, v129, v125, s32
    v_perm_b32 v94, v137, v133, s32
    v_perm_b32 v95, v145, v141, s32
    v_mfma_f32_16x16x32_bf16 v[56:59], v[88:91], v[20:23], v[56:59]
    v_perm_b32 v96, v121, v117, s33
    v_perm_b32 v97, v129, v125, s33
    v_perm_b32 v98, v137, v133, s33
    v_perm_b32 v99, v145, v141, s33
    v_mfma_f32_16x16x32_bf16 v[60:63], v[92:95], v[20:23], v[60:63]
    v_perm_b32 v100, v122, v118, s32
    v_perm_b32 v101, v130, v126, s32
    v_perm_b32 v102, v138, v134, s32
    v_perm_b32 v103, v146, v142, s32
    v_mfma_f32_16x16x32_bf16 v[64:67], v[96:99], v[20:23], v[64:67]
    v_perm_b32 v104, v122, v118, s33
    v_perm_b32 v105, v130, v126, s33
    v_perm_b32 v106, v138, v134, s33
    v_perm_b32 v107, v146, v142, s33
    v_mfma_f32_16x16x32_bf16 v[68:71], v[100:103], v[20:23], v[68:71]
    v_perm_b32 v108, v123, v119, s32
    v_perm_b32 v109, v131, v127, s32
    v_perm_b32 v110, v139, v135, s32
    v_perm_b32 v111, v147, v143, s32
    v_mfma_f32_16x16x32_bf16 v[72:75], v[104:107], v[20:23], v[72:75]
    v_perm_b32 v112, v123, v119, s33
    v_perm_b32 v113, v131, v127, s33
    v_perm_b32 v114, v139, v135, s33
    v_perm_b32 v115, v147, v143, s33
    v_mfma_f32_16x16x32_bf16 v[76:79], v[108:111], v[20:23], v[76:79]
    s_nop 1
    v_mfma_f32_16x16x32_bf16 v[80:83], v[112:115], v[20:23], v[80:83]
    v_readlane_b32 s30, v250, s37
    s_add_u32 s37, s37, 1
    s_and_b32 s28, s30, -2
    s_bitcmp1_b32 s30, 0
    s_cbranch_scc1 L_rv_9
    ds_write_b32 v246, v247 offset:20736
    buffer_load_dwordx4 v[116:119], v2, s[8:11], s28 offen offset:0 nt
    buffer_load_dwordx4 v[120:123], v2, s[8:11], s28 offen offset:1024 nt
    buffer_load_dwordx4 v[124:127], v2, s[8:11], s28 offen offset:2048 nt
    buffer_load_dwordx4 v[128:131], v2, s[8:11], s28 offen offset:3072 nt
    buffer_load_dwordx4 v[132:135], v3, s[8:11], s28 offen offset:0 nt
    buffer_load_dwordx4 v[136:139], v3, s[8:11], s28 offen offset:1024 nt
    buffer_load_dwordx4 v[140:143], v3, s[8:11], s28 offen offset:2048 nt
    buffer_load_dwordx4 v[144:147], v3, s[8:11], s28 offen offset:3072 nt
    s_branch L_rj_10
L_rv_9:
    buffer_load_dwordx4 v[116:119], v4, s[12:15], s28 offen offset:0 nt
    buffer_load_dwordx4 v[120:123], v4, s[12:15], s28 offen offset:1024 nt
    buffer_load_dwordx4 v[124:127], v4, s[12:15], s28 offen offset:2048 nt
    buffer_load_dwordx4 v[128:131], v4, s[12:15], s28 offen offset:3072 nt
    buffer_load_dwordx4 v[132:135], v5, s[12:15], s28 offen offset:0 nt
    buffer_load_dwordx4 v[136:139], v5, s[12:15], s28 offen offset:1024 nt
    buffer_load_dwordx4 v[140:143], v5, s[12:15], s28 offen offset:2048 nt
    buffer_load_dwordx4 v[144:147], v5, s[12:15], s28 offen offset:3072 nt
L_rj_10:
    s_sub_u32 s49, s49, 1
L_vb:
    ds_read_b128 v[32:35], v15
    v_add_u32 v15, 1024, v15
    s_waitcnt lgkmcnt(0)
    v_lshlrev_b32 v24, 16, v32
    v_and_b32 v25, 0xffff0000, v32
    v_lshlrev_b32 v26, 16, v33
    v_and_b32 v27, 0xffff0000, v33
    v_lshlrev_b32 v28, 16, v34
    v_and_b32 v29, 0xffff0000, v34
    v_lshlrev_b32 v30, 16, v35
    v_and_b32 v31, 0xffff0000, v35
    v_max3_f32 v10, v24, v25, v26
    v_max3_f32 v11, v27, v28, v29
    v_max3_f32 v10, v10, v30, v31
    v_max3_f32 v10, v10, v11, v6
    v_mov_b32 v11, v10
    s_nop 1
    v_permlane32_swap_b32 v10, v11
    v_max_f32 v10, v10, v11
    v_mov_b32 v11, v10
    s_nop 1
    v_permlane16_swap_b32 v10, v11
    v_max_f32 v10, v10, v11
    v_sub_f32 v8, v6, v10
    v_mul_f32 v9, s34, v10
    v_mul_f32 v8, s34, v8
    v_mov_b32 v6, v10
    v_exp_f32 v8, v8
    v_fma_f32 v24, v24, s34, -v9
    v_fma_f32 v25, v25, s34, -v9
    v_fma_f32 v26, v26, s34, -v9
    v_fma_f32 v27, v27, s34, -v9
    v_fma_f32 v28, v28, s34, -v9
    v_fma_f32 v29, v29, s34, -v9
    v_fma_f32 v30, v30, s34, -v9
    v_fma_f32 v31, v31, s34, -v9
    v_exp_f32 v24, v24
    v_exp_f32 v25, v25
    v_exp_f32 v26, v26
    v_exp_f32 v27, v27
    v_exp_f32 v28, v28
    v_exp_f32 v29, v29
    v_exp_f32 v30, v30
    v_exp_f32 v31, v31
    v_pk_mul_f32 v[52:53], v[52:53], v[8:9] op_sel_hi:[1,0]
    v_pk_mul_f32 v[54:55], v[54:55], v[8:9] op_sel_hi:[1,0]
    v_pk_mul_f32 v[56:57], v[56:57], v[8:9] op_sel_hi:[1,0]
    v_pk_mul_f32 v[58:59], v[58:59], v[8:9] op_sel_hi:[1,0]
    v_pk_mul_f32 v[60:61], v[60:61], v[8:9] op_sel_hi:[1,0]
    v_pk_mul_f32 v[62:63], v[62:63], v[8:9] op_sel_hi:[1,0]
    v_pk_mul_f32 v[64:65], v[64:65], v[8:9] op_sel_hi:[1,0]
    v_pk_mul_f32 v[66:67], v[66:67], v[8:9] op_sel_hi:[1,0]
    v_pk_mul_f32 v[68:69], v[68:69], v[8:9] op_sel_hi:[1,0]
    v_pk_mul_f32 v[70:71], v[70:71], v[8:9] op_sel_hi:[1,0]
    v_pk_mul_f32 v[72:73], v[72:73], v[8:9] op_sel_hi:[1,0]
    v_pk_mul_f32 v[74:75], v[74:75], v[8:9] op_sel_hi:[1,0]
    v_pk_mul_f32 v[76:77], v[76:77], v[8:9] op_sel_hi:[1,0]
    v_pk_mul_f32 v[78:79], v[78:79], v[8:9] op_sel_hi:[1,0]
    v_pk_mul_f32 v[80:81], v[80:81], v[8:9] op_sel_hi:[1,0]
    v_pk_mul_f32 v[82:83], v[82:83], v[8:9] op_sel_hi:[1,0]
    v_cvt_pk_bf16_f32 v20, v24, v25
    v_cvt_pk_bf16_f32 v21, v26, v27
    v_cvt_pk_bf16_f32 v22, v28, v29
    v_cvt_pk_bf16_f32 v23, v30, v31
    v_add_f32 v10, v24, v25
    v_add_f32 v11, v26, v27
    v_add_f32 v28, v28, v29
    v_add_f32 v30, v30, v31
    v_add_f32 v10, v10, v11
    v_add_f32 v28, v28, v30
    v_add_f32 v10, v10, v28
    v_fma_f32 v7, v7, v8, v10
    s_waitcnt vmcnt(8)
    v_perm_b32 v84, v152, v148, s32
    v_perm_b32 v85, v160, v156, s32
    v_perm_b32 v86, v168, v164, s32
    v_perm_b32 v87, v176, v172, s32
    v_perm_b32 v88, v152, v148, s33
    v_perm_b32 v89, v160, v156, s33
    v_perm_b32 v90, v168, v164, s33
    v_perm_b32 v91, v176, v172, s33
    v_mfma_f32_16x16x32_bf16 v[52:55], v[84:87], v[20:23], v[52:55]
    v_perm_b32 v92, v153, v149, s32
    v_perm_b32 v93, v161, v157, s32
    v_perm_b32 v94, v169, v165, s32
    v_perm_b32 v95, v177, v173, s32
    v_mfma_f32_16x16x32_bf16 v[56:59], v[88:91], v[20:23], v[56:59]
    v_perm_b32 v96, v153, v149, s33
    v_perm_b32 v97, v161, v157, s33
    v_perm_b32 v98, v169, v165, s33
    v_perm_b32 v99, v177, v173, s33
    v_mfma_f32_16x16x32_bf16 v[60:63], v[92:95], v[20:23], v[60:63]
    v_perm_b32 v100, v154, v150, s32
    v_perm_b32 v101, v162, v158, s32
    v_perm_b32 v102, v170, v166, s32
    v_perm_b32 v103, v178, v174, s32
    v_mfma_f32_16x16x32_bf16 v[64:67], v[96:99], v[20:23], v[64:67]
    v_perm_b32 v104, v154, v150, s33
    v_perm_b32 v105, v162, v158, s33
    v_perm_b32 v106, v170, v166, s33
    v_perm_b32 v107, v178, v174, s33
    v_mfma_f32_16x16x32_bf16 v[68:71], v[100:103], v[20:23], v[68:71]
    v_perm_b32 v108, v155, v151, s32
    v_perm_b32 v109, v163, v159, s32
    v_perm_b32 v110, v171, v167, s32
    v_perm_b32 v111, v179, v175, s32
    v_mfma_f32_16x16x32_bf16 v[72:75], v[104:107], v[20:23], v[72:75]
    v_perm_b32 v112, v155, v151, s33
    v_perm_b32 v113, v163, v159, s33
    v_perm_b32 v114, v171, v167, s33
    v_perm_b32 v115, v179, v175, s33
    v_mfma_f32_16x16x32_bf16 v[76:79], v[108:111], v[20:23], v[76:79]
    s_nop 1
    v_mfma_f32_16x16x32_bf16 v[80:83], v[112:115], v[20:23], v[80:83]
    v_readlane_b32 s30, v250, s37
    s_add_u32 s37, s37, 1
    s_and_b32 s28, s30, -2
    buffer_load_dwordx4 v[148:151], v4, s[12:15], s28 offen offset:0 nt
    buffer_load_dwordx4 v[152:155], v4, s[12:15], s28 offen offset:1024 nt
    buffer_load_dwordx4 v[156:159], v4, s[12:15], s28 offen offset:2048 nt
    buffer_load_dwordx4 v[160:163], v4, s[12:15], s28 offen offset:3072 nt
    buffer_load_dwordx4 v[164:167], v5, s[12:15], s28 offen offset:0 nt
    buffer_load_dwordx4 v[168:171], v5, s[12:15], s28 offen offset:1024 nt
    buffer_load_dwordx4 v[172:175], v5, s[12:15], s28 offen offset:2048 nt
    buffer_load_dwordx4 v[176:179], v5, s[12:15], s28 offen offset:3072 nt
L_rj_12:
    s_sub_u32 s49, s49, 1
    s_cmp_lg_u32 s49, 0
    s_cbranch_scc1 L_va
    s_branch L_loop
L_vb0:
    s_branch L_vb
L_tkspin:
    ds_read_b32 v13, v246 offset:20736
    s_waitcnt lgkmcnt(0)
    v_readfirstlane_b32 s30, v13
    s_cmp_lg_u32 s30, -1
    s_cbranch_scc1 L_tkgot
    s_sub_u32 s40, s40, 1
    s_cmp_lg_u32 s40, 0
    s_cbranch_scc1 L_tkspin
    s_branch L_tkgot
L_loop:
    s_waitcnt vmcnt(8)
    ds_read_b32 v13, v246 offset:20736
    v_mfma_f32_16x16x32_bf16 v[84:87], v[116:119], v[16:19], 0
    v_mfma_f32_16x16x32_bf16 v[88:91], v[120:123], v[16:19], 0
    v_mfma_f32_16x16x32_bf16 v[92:95], v[124:127], v[16:19], 0
    v_mfma_f32_16x16x32_bf16 v[96:99], v[128:131], v[16:19], 0
    v_mfma_f32_16x16x32_bf16 v[100:103], v[132:135], v[16:19], 0
    v_mfma_f32_16x16x32_bf16 v[104:107], v[136:139], v[16:19], 0
    v_mfma_f32_16x16x32_bf16 v[108:111], v[140:143], v[16:19], 0
    v_mfma_f32_16x16x32_bf16 v[112:115], v[144:147], v[16:19], 0
    s_waitcnt lgkmcnt(0)
    v_readfirstlane_b32 s30, v13
    s_cmp_eq_u32 s30, -1
    s_cbranch_scc1 L_tkspin
L_tkgot:
    s_cmp_ge_u32 s30, 2048
    s_cselect_b32 s48, 1, 0
    s_cbranch_scc1 L_last
L_dyn_in:
    ds_write_b32 v246, v247 offset:20736
    s_add_u32 s30, s30, s38
    s_and_b32 s30, s30, 2047
    s_lshl_b32 s30, s30, 13
    s_add_u32 s28, s29, s30
    buffer_load_dwordx4 v[116:119], v2, s[8:11], s28 offen offset:0 nt
    buffer_load_dwordx4 v[120:123], v2, s[8:11], s28 offen offset:1024 nt
    buffer_load_dwordx4 v[124:127], v2, s[8:11], s28 offen offset:2048 nt
    buffer_load_dwordx4 v[128:131], v2, s[8:11], s28 offen offset:3072 nt
    buffer_load_dwordx4 v[132:135], v3, s[8:11], s28 offen offset:0 nt
    buffer_load_dwordx4 v[136:139], v3, s[8:11], s28 offen offset:1024 nt
    buffer_load_dwordx4 v[140:143], v3, s[8:11], s28 offen offset:2048 nt
    buffer_load_dwordx4 v[144:147], v3, s[8:11], s28 offen offset:3072 nt
L_last:
    s_nop 4
    s_nop 1
    v_add_f32_dpp v84, v85, v84 row_ror:12 row_mask:0xf bank_mask:0xf
    v_add_f32_dpp v86, v87, v86 row_ror:12 row_mask:0xf bank_mask:0xf
    v_add_f32_dpp v88, v89, v88 row_ror:12 row_mask:0xf bank_mask:0xf
    v_add_f32_dpp v90, v91, v90 row_ror:12 row_mask:0xf bank_mask:0xf
    v_add_f32_dpp v92, v93, v92 row_ror:12 row_mask:0xf bank_mask:0xf
    v_add_f32_dpp v94, v95, v94 row_ror:12 row_mask:0xf bank_mask:0xf
    v_add_f32_dpp v96, v97, v96 row_ror:12 row_mask:0xf bank_mask:0xf
    v_add_f32_dpp v98, v99, v98 row_ror:12 row_mask:0xf bank_mask:0xf
    v_add_f32_dpp v100, v101, v100 row_ror:12 row_mask:0xf bank_mask:0xf
    v_add_f32_dpp v102, v103, v102 row_ror:12 row_mask:0xf bank_mask:0xf
    v_add_f32_dpp v104, v105, v104 row_ror:12 row_mask:0xf bank_mask:0xf
    v_add_f32_dpp v106, v107, v106 row_ror:12 row_mask:0xf bank_mask:0xf
    v_add_f32_dpp v108, v109, v108 row_ror:12 row_mask:0xf bank_mask:0xf
    v_add_f32_dpp v110, v111, v110 row_ror:12 row_mask:0xf bank_mask:0xf
    v_add_f32_dpp v112, v113, v112 row_ror:12 row_mask:0xf bank_mask:0xf
    v_add_f32_dpp v114, v115, v114 row_ror:12 row_mask:0xf bank_mask:0xf
    v_add_f32_dpp v24, v86, v84 row_ror:8 row_mask:0xf bank_mask:0xf
    v_add_f32_dpp v25, v90, v88 row_ror:8 row_mask:0xf bank_mask:0xf
    v_add_f32_dpp v26, v94, v92 row_ror:8 row_mask:0xf bank_mask:0xf
    v_add_f32_dpp v27, v98, v96 row_ror:8 row_mask:0xf bank_mask:0xf
    v_add_f32_dpp v28, v102, v100 row_ror:8 row_mask:0xf bank_mask:0xf
    v_add_f32_dpp v29, v106, v104 row_ror:8 row_mask:0xf bank_mask:0xf
    v_add_f32_dpp v30, v110, v108 row_ror:8 row_mask:0xf bank_mask:0xf
    v_add_f32_dpp v31, v114, v112 row_ror:8 row_mask:0xf bank_mask:0xf
    v_cvt_pk_bf16_f32 v32, v24, v25
    v_cvt_pk_bf16_f32 v33, v26, v27
    v_cvt_pk_bf16_f32 v34, v28, v29
    v_cvt_pk_bf16_f32 v35, v30, v31
    v_lshlrev_b32 v24, 16, v32
    v_and_b32 v25, 0xffff0000, v32
    v_lshlrev_b32 v26, 16, v33
    v_and_b32 v27, 0xffff0000, v33
    v_lshlrev_b32 v28, 16, v34
    v_and_b32 v29, 0xffff0000, v34
    v_lshlrev_b32 v30, 16, v35
    v_and_b32 v31, 0xffff0000, v35
    v_mul_f32 v24, s35, v24
    v_mul_f32 v25, s35, v25
    v_mul_f32 v26, s35, v26
    v_mul_f32 v27, s35, v27
    v_mul_f32 v28, s35, v28
    v_mul_f32 v29, s35, v29
    v_mul_f32 v30, s35, v30
    v_mul_f32 v31, s35, v31
    v_cvt_pk_bf16_f32 v32, v24, v25
    v_cvt_pk_bf16_f32 v33, v26, v27
    v_cvt_pk_bf16_f32 v34, v28, v29
    v_cvt_pk_bf16_f32 v35, v30, v31
    v_lshlrev_b32 v24, 16, v32
    v_and_b32 v25, 0xffff0000, v32
    v_lshlrev_b32 v26, 16, v33
    v_and_b32 v27, 0xffff0000, v33
    v_lshlrev_b32 v28, 16, v34
    v_and_b32 v29, 0xffff0000, v34
    v_lshlrev_b32 v30, 16, v35
    v_and_b32 v31, 0xffff0000, v35
    v_max3_f32 v10, v24, v25, v26
    v_max3_f32 v11, v27, v28, v29
    v_max3_f32 v10, v10, v30, v31
    v_max3_f32 v10, v10, v11, v6
    v_mov_b32 v11, v10
    s_nop 1
    v_permlane32_swap_b32 v10, v11
    v_max_f32 v10, v10, v11
    v_mov_b32 v11, v10
    s_nop 1
    v_permlane16_swap_b32 v10, v11
    v_max_f32 v10, v10, v11
    v_sub_f32 v8, v6, v10
    v_mul_f32 v9, s34, v10
    v_mul_f32 v8, s34, v8
    v_mov_b32 v6, v10
    v_exp_f32 v8, v8
    v_fma_f32 v24, v24, s34, -v9
    v_fma_f32 v25, v25, s34, -v9
    v_fma_f32 v26, v26, s34, -v9
    v_fma_f32 v27, v27, s34, -v9
    v_fma_f32 v28, v28, s34, -v9
    v_fma_f32 v29, v29, s34, -v9
    v_fma_f32 v30, v30, s34, -v9
    v_fma_f32 v31, v31, s34, -v9
    v_exp_f32 v24, v24
    v_exp_f32 v25, v25
    v_exp_f32 v26, v26
    v_exp_f32 v27, v27
    v_exp_f32 v28, v28
    v_exp_f32 v29, v29
    v_exp_f32 v30, v30
    v_exp_f32 v31, v31
    v_pk_mul_f32 v[52:53], v[52:53], v[8:9] op_sel_hi:[1,0]
    v_pk_mul_f32 v[54:55], v[54:55], v[8:9] op_sel_hi:[1,0]
    v_pk_mul_f32 v[56:57], v[56:57], v[8:9] op_sel_hi:[1,0]
    v_pk_mul_f32 v[58:59], v[58:59], v[8:9] op_sel_hi:[1,0]
    v_pk_mul_f32 v[60:61], v[60:61], v[8:9] op_sel_hi:[1,0]
    v_pk_mul_f32 v[62:63], v[62:63], v[8:9] op_sel_hi:[1,0]
    v_pk_mul_f32 v[64:65], v[64:65], v[8:9] op_sel_hi:[1,0]
    v_pk_mul_f32 v[66:67], v[66:67], v[8:9] op_sel_hi:[1,0]
    v_pk_mul_f32 v[68:69], v[68:69], v[8:9] op_sel_hi:[1,0]
    v_pk_mul_f32 v[70:71], v[70:71], v[8:9] op_sel_hi:[1,0]
    v_pk_mul_f32 v[72:73], v[72:73], v[8:9] op_sel_hi:[1,0]
    v_pk_mul_f32 v[74:75], v[74:75], v[8:9] op_sel_hi:[1,0]
    v_pk_mul_f32 v[76:77], v[76:77], v[8:9] op_sel_hi:[1,0]
    v_pk_mul_f32 v[78:79], v[78:79], v[8:9] op_sel_hi:[1,0]
    v_pk_mul_f32 v[80:81], v[80:81], v[8:9] op_sel_hi:[1,0]
    v_pk_mul_f32 v[82:83], v[82:83], v[8:9] op_sel_hi:[1,0]
    v_cvt_pk_bf16_f32 v20, v24, v25
    v_cvt_pk_bf16_f32 v21, v26, v27
    v_cvt_pk_bf16_f32 v22, v28, v29
    v_cvt_pk_bf16_f32 v23, v30, v31
    v_add_f32 v10, v24, v25
    v_add_f32 v11, v26, v27
    v_add_f32 v28, v28, v29
    v_add_f32 v30, v30, v31
    v_add_f32 v10, v10, v11
    v_add_f32 v28, v28, v30
    v_add_f32 v10, v10, v28
    v_fma_f32 v7, v7, v8, v10
    s_waitcnt vmcnt(8)
    s_cmp_eq_u32 s48, 0
    s_cbranch_scc1 L_nw0
    s_waitcnt vmcnt(0)
L_nw0:
    v_perm_b32 v84, v152, v148, s32
    v_perm_b32 v85, v160, v156, s32
    v_perm_b32 v86, v168, v164, s32
    v_perm_b32 v87, v176, v172, s32
    v_perm_b32 v88, v152, v148, s33
    v_perm_b32 v89, v160, v156, s33
    v_perm_b32 v90, v168, v164, s33
    v_perm_b32 v91, v176, v172, s33
    v_mfma_f32_16x16x32_bf16 v[52:55], v[84:87], v[20:23], v[52:55]
    v_perm_b32 v92, v153, v149, s32
    v_perm_b32 v93, v161, v157, s32
    v_perm_b32 v94, v169, v165, s32
    v_perm_b32 v95, v177, v173, s32
    v_mfma_f32_16x16x32_bf16 v[56:59], v[88:91], v[20:23], v[56:59]
    v_perm_b32 v96, v153, v149, s33
    v_perm_b32 v97, v161, v157, s33
    v_perm_b32 v98, v169, v165, s33
    v_perm_b32 v99, v177, v173, s33
    v_mfma_f32_16x16x32_bf16 v[60:63], v[92:95], v[20:23], v[60:63]
    v_perm_b32 v100, v154, v150, s32
    v_perm_b32 v101, v162, v158, s32
    v_perm_b32 v102, v170, v166, s32
    v_perm_b32 v103, v178, v174, s32
    v_mfma_f32_16x16x32_bf16 v[64:67], v[96:99], v[20:23], v[64:67]
    v_perm_b32 v104, v154, v150, s33
    v_perm_b32 v105, v162, v158, s33
    v_perm_b32 v106, v170, v166, s33
    v_perm_b32 v107, v178, v174, s33
    v_mfma_f32_16x16x32_bf16 v[68:71], v[100:103], v[20:23], v[68:71]
    v_perm_b32 v108, v155, v151, s32
    v_perm_b32 v109, v163, v159, s32
    v_perm_b32 v110, v171, v167, s32
    v_perm_b32 v111, v179, v175, s32
    v_mfma_f32_16x16x32_bf16 v[72:75], v[104:107], v[20:23], v[72:75]
    v_perm_b32 v112, v155, v151, s33
    v_perm_b32 v113, v163, v159, s33
    v_perm_b32 v114, v171, v167, s33
    v_perm_b32 v115, v179, v175, s33
    v_mfma_f32_16x16x32_bf16 v[76:79], v[108:111], v[20:23], v[76:79]
    s_nop 1
    v_mfma_f32_16x16x32_bf16 v[80:83], v[112:115], v[20:23], v[80:83]
    s_cbranch_scc0 L_done
    buffer_load_dwordx4 v[148:151], v4, s[12:15], s28 offen offset:0 nt
    buffer_load_dwordx4 v[152:155], v4, s[12:15], s28 offen offset:1024 nt
    buffer_load_dwordx4 v[156:159], v4, s[12:15], s28 offen offset:2048 nt
    buffer_load_dwordx4 v[160:163], v4, s[12:15], s28 offen offset:3072 nt
    buffer_load_dwordx4 v[164:167], v5, s[12:15], s28 offen offset:0 nt
    buffer_load_dwordx4 v[168:171], v5, s[12:15], s28 offen offset:1024 nt
    buffer_load_dwordx4 v[172:175], v5, s[12:15], s28 offen offset:2048 nt
    buffer_load_dwordx4 v[176:179], v5, s[12:15], s28 offen offset:3072 nt
    s_branch L_loop
L_done:
    v_mov_b32 v11, v7
    s_nop 1
    v_permlane32_swap_b32 v7, v11
    v_add_f32 v7, v7, v11
    v_mov_b32 v11, v7
    s_nop 1
    v_permlane16_swap_b32 v7, v11
    v_add_f32 v7, v7, v11
    s_mov_b32 exec_lo, 0x000f000f
    s_mov_b32 exec_hi, 0x000f000f
    ds_write_b128 v245, v[52:55] offset:2048
    ds_write_b128 v245, v[56:59] offset:2112
    ds_write_b128 v245, v[60:63] offset:2176
    ds_write_b128 v245, v[64:67] offset:2240
    ds_write_b128 v245, v[68:71] offset:2304
    ds_write_b128 v245, v[72:75] offset:2368
    ds_write_b128 v245, v[76:79] offset:2432
    ds_write_b128 v245, v[80:83] offset:2496
    s_mov_b64 exec, 0xf
    ds_write_b64 v244, v[6:7] offset:20480
    s_mov_b64 exec, -1
    s_waitcnt lgkmcnt(0)
    s_barrier
    s_cmp_lt_u32 s43, 32
    s_cbranch_scc1 L_service2
    s_branch L_fin
L_hdone:
L_mrg:
    s_sub_u32 s6, s3, 4
    s_lshl_b32 s30, s6, 6
    v_and_b32 v248, 3, v1
    v_lshlrev_b32 v248, 3, v248
    v_add_u32 v248, s30, v248
    s_mul_i32 s30, s6, 576
    v_lshlrev_b32 v249, 3, v1
    v_add_u32 v249, s30, v249
    s_add_u32 s30, s42, s41
    s_mul_i32 s31, s30, 37
    s_lshr_b32 s31, s31, 8
    s_mul_i32 s51, s31, 7
    s_sub_u32 s30, s30, s51
    s_mul_i32 s31, s31, 3
    s_lshr_b32 s29, s30, 1
    s_add_u32 s29, s29, s31
    s_cmp_ge_u32 s29, 12
    s_cselect_b32 s31, 12, 0
    s_sub_u32 s29, s29, s31
    s_add_u32 s29, s29, 20
    s_bitcmp1_b32 s30, 0
    s_cselect_b32 s51, 1, 0
    s_sub_u32 s30, s42, 28
    s_cmp_lt_u32 s43, 32
    s_cselect_b32 s29, s30, s29
    s_cselect_b32 s51, 5, s51
    s_cselect_b32 s38, 16, 48
    s_lshl_b32 s29, s29, 2
    s_add_u32 s29, s29, s6
    s_add_u32 s29, s29, 1560
    s_lshl_b32 s31, s42, 3
    s_sub_u32 s31, s31, 217
    s_mul_i32 s30, s42, 37
    s_lshr_b32 s30, s30, 8
    s_add_u32 s42, s42, s30
    s_cmp_lt_u32 s43, 32
    s_cselect_b32 s42, s31, s42
    s_lshl_b32 s30, s41, 5
    s_add_u32 s30, s30, s42
    s_lshl_b32 s30, s30, 11
    s_add_u32 s30, s30, 262144
    s_lshl_b32 s31, s6, 9
    s_add_u32 s49, s30, s31
    s_lshl_b32 s30, s41, 10
    s_lshl_b32 s31, s6, 8
    s_add_u32 s30, s30, s31
    s_lshl_b32 s31, s42, 3
    s_add_u32 s30, s30, s31
    s_add_u32 s50, s30, 196608
    v_lshlrev_b32 v15, 3, v1
    s_mov_b32 s37, 2048
    s_mov_b32 s28, 0
    s_cmp_eq_u32 s3, 6
    s_cselect_b32 s37, 1976, s37
    s_cmp_eq_u32 s3, 7
    s_cselect_b32 s37, 1976, s37
    s_cmp_lt_u32 s43, 32
    s_cselect_b32 s37, 1828, s37
L_tk0:
    s_mov_b32 s40, 1048576
L_tk:
    ds_read_b32 v13, v246 offset:20736
    s_waitcnt lgkmcnt(0)
    v_readfirstlane_b32 s30, v13
    s_cmp_eq_u32 s30, -1
    s_cbranch_scc1 L_tkreq
    s_sleep 2
    s_sub_u32 s40, s40, 1
    s_cmp_lg_u32 s40, 0
    s_cbranch_scc1 L_tk
    s_branch L_tkend
L_tkreq:
    s_cmp_eq_u32 s51, 0
    s_cbranch_scc1 L_tkdraw
    s_mov_b32 s30, s29
    s_add_u32 s29, s29, s38
    s_sub_u32 s51, s51, 1
    s_branch L_tkgive
L_tkdraw:
    s_mov_b32 s30, 2048
    s_cmp_ge_u32 s28, s37
    s_cbranch_scc1 L_tkgive
    v_mov_b32 v13, 1
    s_mov_b64 exec, 1
    buffer_atomic_add v13, v12, s[16:19], 0 offen sc0
    s_mov_b64 exec, -1
    s_waitcnt vmcnt(0)
    v_readfirstlane_b32 s30, v13
    s_mul_i32 s30, s30, 16
    s_add_u32 s30, s30, s36
    s_mov_b32 s28, s30
L_tkgive:
    v_mov_b32 v13, s30
    ds_write_b32 v246, v13 offset:20736
    s_cmp_lt_u32 s30, 2048
    s_cbranch_scc1 L_tk0
L_tkend:
    s_waitcnt lgkmcnt(0)
    s_barrier
    ds_read_b64 v[24:25], v248 offset:20480
    ds_read_b64 v[84:85], v249 offset:2048
    ds_read_b64 v[86:87], v249 offset:4352
    ds_read_b64 v[88:89], v249 offset:6656
    ds_read_b64 v[90:91], v249 offset:8960
    s_waitcnt lgkmcnt(4)
    v_max_f32_dpp v26, v24, v24 quad_perm:[1,0,3,2] row_mask:0xf bank_mask:0xf
    v_mul_f32 v28, s34, v24
    s_nop 0
    v_max_f32_dpp v26, v26, v26 quad_perm:[2,3,0,1] row_mask:0xf bank_mask:0xf
    v_mul_f32 v29, s34, v26
    v_sub_f32 v28, v28, v29
    v_exp_f32 v28, v28
    s_mov_b32 s44, 0x55555555
    s_mov_b32 s45, 0x55555555
    v_mul_f32 v27, v28, v25
    s_waitcnt lgkmcnt(3)
    v_mul_f32_dpp v36, v28, v84 row_newbcast:0 row_mask:0xf bank_mask:0xf
    v_mul_f32_dpp v37, v28, v85 row_newbcast:0 row_mask:0xf bank_mask:0xf
    v_add_f32_dpp v27, v27, v27 quad_perm:[1,0,3,2] row_mask:0xf bank_mask:0xf
    s_waitcnt lgkmcnt(2)
    v_fmac_f32_dpp v36, v28, v86 row_newbcast:1 row_mask:0xf bank_mask:0xf
    v_fmac_f32_dpp v37, v28, v87 row_newbcast:1 row_mask:0xf bank_mask:0xf
    v_add_f32_dpp v27, v27, v27 quad_perm:[2,3,0,1] row_mask:0xf bank_mask:0xf
    s_waitcnt lgkmcnt(1)
    v_fmac_f32_dpp v36, v28, v88 row_newbcast:2 row_mask:0xf bank_mask:0xf
    v_fmac_f32_dpp v37, v28, v89 row_newbcast:2 row_mask:0xf bank_mask:0xf
    s_mov_b64 exec, 1
    buffer_store_dwordx2 v[26:27], v15, s[16:19], s50 offen sc1
    s_mov_b64 exec, -1
    s_waitcnt lgkmcnt(0)
    v_fmac_f32_dpp v36, v28, v90 row_newbcast:3 row_mask:0xf bank_mask:0xf
    v_fmac_f32_dpp v37, v28, v91 row_newbcast:3 row_mask:0xf bank_mask:0xf
    s_nop 0
    v_mov_b32_dpp v38, v36 quad_perm:[1,1,3,3] row_mask:0xf bank_mask:0xf
    v_mov_b32_dpp v39, v37 quad_perm:[1,1,3,3] row_mask:0xf bank_mask:0xf
    s_mov_b64 exec, s[44:45]
    buffer_store_dwordx4 v[36:39], v15, s[16:19], s49 offen sc1
    s_mov_b64 exec, -1
    s_cmp_lt_u32 s43, 32
    s_cbranch_scc1 L_service2
    s_branch L_fin
L_service:
    s_cmp_lg_u32 s3, 7
    s_cbranch_scc1 L_noclr2
    v_mov_b32 v36, 0
    v_mov_b32 v37, 0
    v_mov_b32 v38, 0
    v_mov_b32 v39, 0
    ds_write_b128 v4, v[36:39] offset:20992
    ds_write_b128 v4, v[36:39] offset:22016
    v_lshlrev_b32 v11, 2, v1
    ds_write_b32 v11, v36 offset:20736
L_noclr2:
    s_and_b32 s41, s43, 7
    s_lshr_b32 s38, s43, 3
    v_lshrrev_b32 v11, 4, v1
    v_lshrrev_b32 v10, 5, v1
    v_and_b32 v8, 1, v11
    v_lshl_add_u32 v8, v8, 1, v10
    v_and_b32 v10, 15, v1
    v_lshl_add_u32 v2, v10, 2, v8
    s_lshl_b32 s30, s3, 6
    v_add_u32 v2, s30, v2
    v_and_b32 v10, 3, v1
    v_lshl_add_u32 v3, v10, 2, v8
    s_lshl_b32 s30, s43, 4
    v_add_u32 v3, s30, v3
    v_and_b32 v10, 1, v1
    v_lshlrev_b32 v10, 6, v10
    v_lshl_add_u32 v13, v11, 4, v10
    v_bfe_u32 v15, v1, 3, 1
    v_lshl_add_u32 v15, v15, 2, v11
    v_mul_u32_u24 v7, 49152, v15
    v_and_b32 v10, 7, v1
    v_lshl_add_u32 v7, v10, 4, v7
    s_mul_i32 s29, s3, 393216
    v_and_b32 v10, 3, v1
    v_lshlrev_b32 v10, 4, v10
    v_lshl_add_u32 v5, v11, 14, v10
    s_lshl_b32 s36, s41, 11
    s_lshl_b32 s31, s38, 9
    s_add_u32 s36, s36, s31
    s_lshl_b32 s31, s3, 6
    s_add_u32 s36, s36, s31
    s_add_u32 s36, s36, 1048576
    s_add_u32 s5, s36, 0x10000
    v_bfe_u32 v10, v1, 1, 2
    v_lshlrev_b32 v14, 11, v10
    v_and_b32 v10, 1, v1
    v_lshl_add_u32 v14, v10, 5, v14
    v_lshl_add_u32 v14, v11, 4, v14
    s_lshl_b32 s37, s3, 13
    s_lshl_b32 s31, s43, 6
    s_add_u32 s37, s37, s31
    s_add_u32 s37, s37, 131072
    v_mov_b32 v116, -1
    v_mov_b32 v117, -1
    v_mov_b32 v118, -1
    v_mov_b32 v119, -1
    s_and_b32 s49, s43, 1
    s_mul_i32 s28, s49, 1572864
    s_add_u32 s28, s28, s29
    s_lshr_b32 s30, s43, 1
    s_lshl_b32 s31, s30, 7
    s_add_u32 s28, s28, s31
    s_lshl_b32 s50, s30, 10
    s_lshl_b32 s31, s49, 3
    s_add_u32 s50, s50, s31
    s_add_u32 s50, s50, 32768
    s_lshl_b32 s51, s3, 7
    s_lshl_b32 s49, s49, 9
    s_add_u32 s49, s49, s51
    v_and_b32 v9, 7, v1
    v_lshlrev_b32 v9, 5, v9
    v_lshl_add_u32 v9, v11, 3, v9
    s_lshl_b32 s31, s3, 8
    v_add_u32 v9, s31, v9
    s_waitcnt lgkmcnt(0)
    s_mov_b32 s20, s82
    s_mov_b32 s21, s83
    s_mov_b32 s22, 0x400
    s_mov_b32 s23, 0x00020000
    s_mov_b32 s24, s84
    s_mov_b32 s25, s85
    s_mov_b32 s26, 0x300000
    s_mov_b32 s27, 0x00020000
    s_mov_b32 s16, s90
    s_mov_b32 s17, s91
    s_mov_b32 s18, 0x20000000
    s_mov_b32 s19, 0x00020000
    s_load_dword s4, s[90:91], 0
    s_cmp_lt_u32 s3, 4
    s_cbranch_scc1 L_mod1b
    s_mov_b32 exec_lo, 0x000f000f
    s_mov_b32 exec_hi, 0x000f000f
    buffer_store_dwordx4 v[116:119], v5, s[16:19], s36 offen sc1
    buffer_store_dwordx4 v[116:119], v5, s[16:19], s5 offen sc1
    s_mov_b64 exec, 0x00ff00ff
    buffer_store_dwordx4 v[116:119], v14, s[16:19], s37 offen sc1
    s_mov_b64 exec, -1
    s_branch L_mod1a
L_mod1b:
    buffer_load_dwordx4 v[244:247], v13, s[20:23], s49 offen
    buffer_load_dwordx4 v[52:55], v7, s[24:27], s28 offen nt
    s_add_u32 s30, s28, 6144
    buffer_load_dwordx4 v[56:59], v7, s[24:27], s30 offen nt
    s_add_u32 s30, s28, 12288
    buffer_load_dwordx4 v[60:63], v7, s[24:27], s30 offen nt
    s_add_u32 s30, s28, 18432
    buffer_load_dwordx4 v[64:67], v7, s[24:27], s30 offen nt
    s_add_u32 s30, s28, 24576
    buffer_load_dwordx4 v[68:71], v7, s[24:27], s30 offen nt
    s_add_u32 s30, s28, 30720
    buffer_load_dwordx4 v[72:75], v7, s[24:27], s30 offen nt
    s_add_u32 s30, s28, 36864
    buffer_load_dwordx4 v[76:79], v7, s[24:27], s30 offen nt
    s_add_u32 s30, s28, 43008
    buffer_load_dwordx4 v[80:83], v7, s[24:27], s30 offen nt
    s_mov_b32 exec_lo, 0x000f000f
    s_mov_b32 exec_hi, 0x000f000f
    buffer_store_dwordx4 v[116:119], v5, s[16:19], s36 offen sc1
    buffer_store_dwordx4 v[116:119], v5, s[16:19], s5 offen sc1
    s_mov_b64 exec, 0x00ff00ff
    buffer_store_dwordx4 v[116:119], v14, s[16:19], s37 offen sc1
    s_mov_b64 exec, -1
    s_waitcnt vmcnt(11)
    v_lshlrev_b32 v24, 16, v244
    v_and_b32 v25, 0xffff0000, v244
    v_lshlrev_b32 v26, 16, v245
    v_and_b32 v27, 0xffff0000, v245
    v_lshlrev_b32 v28, 16, v246
    v_and_b32 v29, 0xffff0000, v246
    v_lshlrev_b32 v30, 16, v247
    v_and_b32 v31, 0xffff0000, v247
    v_mul_f32 v36, s34, v24
    v_mul_f32 v37, s34, v25
    v_mul_f32 v38, s34, v26
    v_mul_f32 v39, s34, v27
    v_mul_f32 v40, s34, v28
    v_mul_f32 v41, s34, v29
    v_mul_f32 v42, s34, v30
    v_mul_f32 v43, s34, v31
    v_exp_f32 v36, -v36
    v_exp_f32 v37, -v37
    v_exp_f32 v38, -v38
    v_exp_f32 v39, -v39
    v_exp_f32 v40, -v40
    v_exp_f32 v41, -v41
    v_exp_f32 v42, -v42
    v_exp_f32 v43, -v43
    v_add_f32 v36, 1.0, v36
    v_add_f32 v37, 1.0, v37
    v_add_f32 v38, 1.0, v38
    v_add_f32 v39, 1.0, v39
    v_add_f32 v40, 1.0, v40
    v_add_f32 v41, 1.0, v41
    v_add_f32 v42, 1.0, v42
    v_add_f32 v43, 1.0, v43
    v_rcp_f32 v36, v36
    v_rcp_f32 v37, v37
    v_rcp_f32 v38, v38
    v_rcp_f32 v39, v39
    v_rcp_f32 v40, v40
    v_rcp_f32 v41, v41
    v_rcp_f32 v42, v42
    v_rcp_f32 v43, v43
    s_nop 0
    v_mul_f32 v24, v24, v36
    v_mul_f32 v25, v25, v37
    v_mul_f32 v26, v26, v38
    v_mul_f32 v27, v27, v39
    v_mul_f32 v28, v28, v40
    v_mul_f32 v29, v29, v41
    v_mul_f32 v30, v30, v42
    v_mul_f32 v31, v31, v43
    v_cvt_pk_bf16_f32 v244, v24, v25
    v_cvt_pk_bf16_f32 v245, v26, v27
    v_cvt_pk_bf16_f32 v246, v28, v29
    v_cvt_pk_bf16_f32 v247, v30, v31
    s_waitcnt vmcnt(3)
    v_perm_b32 v84, v56, v52, s32
    v_perm_b32 v85, v64, v60, s32
    v_perm_b32 v86, v72, v68, s32
    v_perm_b32 v87, v80, v76, s32
    v_perm_b32 v88, v56, v52, s33
    v_perm_b32 v89, v64, v60, s33
    v_perm_b32 v90, v72, v68, s33
    v_perm_b32 v91, v80, v76, s33
    v_perm_b32 v92, v57, v53, s32
    v_perm_b32 v93, v65, v61, s32
    v_perm_b32 v94, v73, v69, s32
    v_perm_b32 v95, v81, v77, s32
    v_perm_b32 v96, v57, v53, s33
    v_perm_b32 v97, v65, v61, s33
    v_perm_b32 v98, v73, v69, s33
    v_perm_b32 v99, v81, v77, s33
    v_perm_b32 v100, v58, v54, s32
    v_perm_b32 v101, v66, v62, s32
    v_perm_b32 v102, v74, v70, s32
    v_perm_b32 v103, v82, v78, s32
    v_perm_b32 v104, v58, v54, s33
    v_perm_b32 v105, v66, v62, s33
    v_perm_b32 v106, v74, v70, s33
    v_perm_b32 v107, v82, v78, s33
    v_perm_b32 v108, v59, v55, s32
    v_perm_b32 v109, v67, v63, s32
    v_perm_b32 v110, v75, v71, s32
    v_perm_b32 v111, v83, v79, s32
    v_perm_b32 v112, v59, v55, s33
    v_perm_b32 v113, v67, v63, s33
    v_perm_b32 v114, v75, v71, s33
    v_perm_b32 v115, v83, v79, s33
    s_nop 1
    v_mfma_f32_16x16x32_bf16 v[52:55], v[244:247], v[84:87], 0
    v_mfma_f32_16x16x32_bf16 v[56:59], v[244:247], v[88:91], 0
    v_mfma_f32_16x16x32_bf16 v[60:63], v[244:247], v[92:95], 0
    v_mfma_f32_16x16x32_bf16 v[64:67], v[244:247], v[96:99], 0
    v_mfma_f32_16x16x32_bf16 v[68:71], v[244:247], v[100:103], 0
    v_mfma_f32_16x16x32_bf16 v[72:75], v[244:247], v[104:107], 0
    v_mfma_f32_16x16x32_bf16 v[76:79], v[244:247], v[108:111], 0
    v_mfma_f32_16x16x32_bf16 v[80:83], v[244:247], v[112:115], 0
    s_nop 0
    v_add_f32_dpp v24, v53, v52 row_ror:8 row_mask:0x1 bank_mask:0xf
    v_add_f32_dpp v25, v57, v56 row_ror:8 row_mask:0x1 bank_mask:0xf
    v_add_f32_dpp v24, v61, v60 row_ror:8 row_mask:0x2 bank_mask:0xf
    v_add_f32_dpp v25, v65, v64 row_ror:8 row_mask:0x2 bank_mask:0xf
    v_add_f32_dpp v24, v69, v68 row_ror:8 row_mask:0x4 bank_mask:0xf
    v_add_f32_dpp v25, v73, v72 row_ror:8 row_mask:0x4 bank_mask:0xf
    v_add_f32_dpp v24, v77, v76 row_ror:8 row_mask:0x8 bank_mask:0xf
    v_add_f32_dpp v25, v81, v80 row_ror:8 row_mask:0x8 bank_mask:0xf
    s_mov_b32 exec_lo, 0x00ff00ff
    s_mov_b32 exec_hi, 0x00ff00ff
    ds_write_b64 v9, v[24:25] offset:0
    s_mov_b64 exec, -1
L_mod1a:
    s_waitcnt lgkmcnt(0)
    s_mul_i32 s39, s4, 1664525
    s_add_u32 s39, s39, 1013904223
    s_or_b32 s39, s39, 1
    s_barrier
    s_cmp_lg_u32 s3, 0
    s_cbranch_scc1 L_mod1skip
    v_lshlrev_b32 v10, 2, v1
    ds_read2st64_b32 v[36:37], v10 offset0:0 offset1:1
    ds_read2st64_b32 v[38:39], v10 offset0:2 offset1:3
    s_waitcnt lgkmcnt(0)
    v_pk_add_f32 v[36:37], v[36:37], v[38:39]
    v_add_f32 v36, v36, v37
    v_mov_b32 v37, s39
    buffer_store_dwordx2 v[36:37], v4, s[16:19], s50 offen sc1
L_mod1skip:
    s_barrier
L_blk2:
    buffer_load_dwordx4 v[32:35], v13, s[20:23], s51 offen
    s_mov_b32 s8, s64
    s_mov_b32 s9, s65
    s_mov_b32 s10, 0x400
    s_mov_b32 s11, 0x00020000
    v_lshlrev_b32 v10, 1, v2
    buffer_load_ushort v44, v10, s[8:11], 0 offen
    v_mov_b32 v244, -1
    v_mov_b32 v245, -1
    v_mov_b32 v246, -1
    v_mov_b32 v247, -1
    s_lshl_b32 s28, s43, 7
    s_add_u32 s28, s28, s29
    s_add_u32 s28, s28, 2048
    buffer_load_dwordx4 v[52:55], v7, s[24:27], s28 offen nt
    s_add_u32 s30, s28, 6144
    buffer_load_dwordx4 v[56:59], v7, s[24:27], s30 offen nt
    s_add_u32 s30, s28, 12288
    buffer_load_dwordx4 v[60:63], v7, s[24:27], s30 offen nt
    s_add_u32 s30, s28, 18432
    buffer_load_dwordx4 v[64:67], v7, s[24:27], s30 offen nt
    s_add_u32 s30, s28, 24576
    buffer_load_dwordx4 v[68:71], v7, s[24:27], s30 offen nt
    s_add_u32 s30, s28, 30720
    buffer_load_dwordx4 v[72:75], v7, s[24:27], s30 offen nt
    s_add_u32 s30, s28, 36864
    buffer_load_dwordx4 v[76:79], v7, s[24:27], s30 offen nt
    s_add_u32 s30, s28, 43008
    buffer_load_dwordx4 v[80:83], v7, s[24:27], s30 offen nt
    s_mov_b32 s20, s72
    s_mov_b32 s21, s73
    s_mov_b32 s22, 0x400000
    s_mov_b32 s23, 0x00020000
    v_lshlrev_b32 v15, 10, v11
    v_and_b32 v10, 15, v1
    v_lshl_add_u32 v15, v10, 4, v15
    s_lshl_b32 s28, s41, 19
    s_lshl_b32 s31, s3, 16
    s_add_u32 s28, s28, s31
    s_lshl_b32 s31, s38, 8
    s_add_u32 s28, s28, s31
    buffer_load_dwordx4 v[180:183], v15, s[20:23], s28 offen nt
    s_add_u32 s30, s28, 4096
    buffer_load_dwordx4 v[184:187], v15, s[20:23], s30 offen nt
    s_add_u32 s30, s28, 8192
    buffer_load_dwordx4 v[188:191], v15, s[20:23], s30 offen nt
    s_add_u32 s30, s28, 12288
    buffer_load_dwordx4 v[192:195], v15, s[20:23], s30 offen nt
    s_add_u32 s30, s28, 16384
    buffer_load_dwordx4 v[196:199], v15, s[20:23], s30 offen nt
    s_add_u32 s30, s28, 20480
    buffer_load_dwordx4 v[200:203], v15, s[20:23], s30 offen nt
    s_add_u32 s30, s28, 24576
    buffer_load_dwordx4 v[204:207], v15, s[20:23], s30 offen nt
    s_add_u32 s30, s28, 28672
    buffer_load_dwordx4 v[208:211], v15, s[20:23], s30 offen nt
    v_and_b32 v8, 15, v1
    v_lshlrev_b32 v8, 5, v8
    v_lshl_add_u32 v8, v11, 3, v8
    s_lshl_b32 s30, s3, 9
    v_add_u32 v8, s30, v8
    s_mov_b32 s24, s80
    s_mov_b32 s25, s81
    s_mov_b32 s26, 0x1c0000
    s_mov_b32 s27, 0x00020000
    s_waitcnt vmcnt(8)
    v_lshlrev_b32 v44, 16, v44
    v_lshlrev_b32 v24, 16, v32
    v_and_b32 v25, 0xffff0000, v32
    v_lshlrev_b32 v26, 16, v33
    v_and_b32 v27, 0xffff0000, v33
    v_lshlrev_b32 v28, 16, v34
    v_and_b32 v29, 0xffff0000, v34
    v_lshlrev_b32 v30, 16, v35
    v_and_b32 v31, 0xffff0000, v35
    v_mul_f32 v36, s34, v24
    v_mul_f32 v37, s34, v25
    v_mul_f32 v38, s34, v26
    v_mul_f32 v39, s34, v27
    v_mul_f32 v40, s34, v28
    v_mul_f32 v41, s34, v29
    v_mul_f32 v42, s34, v30
    v_mul_f32 v43, s34, v31
    v_exp_f32 v36, -v36
    v_exp_f32 v37, -v37
    v_exp_f32 v38, -v38
    v_exp_f32 v39, -v39
    v_exp_f32 v40, -v40
    v_exp_f32 v41, -v41
    v_exp_f32 v42, -v42
    v_exp_f32 v43, -v43
    v_add_f32 v36, 1.0, v36
    v_add_f32 v37, 1.0, v37
    v_add_f32 v38, 1.0, v38
    v_add_f32 v39, 1.0, v39
    v_add_f32 v40, 1.0, v40
    v_add_f32 v41, 1.0, v41
    v_add_f32 v42, 1.0, v42
    v_add_f32 v43, 1.0, v43
    v_rcp_f32 v36, v36
    v_rcp_f32 v37, v37
    v_rcp_f32 v38, v38
    v_rcp_f32 v39, v39
    v_rcp_f32 v40, v40
    v_rcp_f32 v41, v41
    v_rcp_f32 v42, v42
    v_rcp_f32 v43, v43
    s_nop 0
    v_mul_f32 v24, v24, v36
    v_mul_f32 v25, v25, v37
    v_mul_f32 v26, v26, v38
    v_mul_f32 v27, v27, v39
    v_mul_f32 v28, v28, v40
    v_mul_f32 v29, v29, v41
    v_mul_f32 v30, v30, v42
    v_mul_f32 v31, v31, v43
    v_cvt_pk_bf16_f32 v32, v24, v25
    v_cvt_pk_bf16_f32 v33, v26, v27
    v_cvt_pk_bf16_f32 v34, v28, v29
    v_cvt_pk_bf16_f32 v35, v30, v31
    v_perm_b32 v84, v56, v52, s32
    v_perm_b32 v85, v64, v60, s32
    v_perm_b32 v86, v72, v68, s32
    v_perm_b32 v87, v80, v76, s32
    v_perm_b32 v88, v56, v52, s33
    v_perm_b32 v89, v64, v60, s33
    v_perm_b32 v90, v72, v68, s33
    v_perm_b32 v91, v80, v76, s33
    v_perm_b32 v92, v57, v53, s32
    v_perm_b32 v93, v65, v61, s32
    v_perm_b32 v94, v73, v69, s32
    v_perm_b32 v95, v81, v77, s32
    v_perm_b32 v96, v57, v53, s33
    v_perm_b32 v97, v65, v61, s33
    v_perm_b32 v98, v73, v69, s33
    v_perm_b32 v99, v81, v77, s33
    v_perm_b32 v100, v58, v54, s32
    v_perm_b32 v101, v66, v62, s32
    v_perm_b32 v102, v74, v70, s32
    v_perm_b32 v103, v82, v78, s32
    v_perm_b32 v104, v58, v54, s33
    v_perm_b32 v105, v66, v62, s33
    v_perm_b32 v106, v74, v70, s33
    v_perm_b32 v107, v82, v78, s33
    v_perm_b32 v108, v59, v55, s32
    v_perm_b32 v109, v67, v63, s32
    v_perm_b32 v110, v75, v71, s32
    v_perm_b32 v111, v83, v79, s32
    v_perm_b32 v112, v59, v55, s33
    v_perm_b32 v113, v67, v63, s33
    v_perm_b32 v114, v75, v71, s33
    v_perm_b32 v115, v83, v79, s33
    s_nop 1
    v_mfma_f32_16x16x32_bf16 v[52:55], v[32:35], v[84:87], 0
    v_mfma_f32_16x16x32_bf16 v[56:59], v[32:35], v[88:91], 0
    v_mfma_f32_16x16x32_bf16 v[60:63], v[32:35], v[92:95], 0
    v_mfma_f32_16x16x32_bf16 v[64:67], v[32:35], v[96:99], 0
    v_mfma_f32_16x16x32_bf16 v[68:71], v[32:35], v[100:103], 0
    v_mfma_f32_16x16x32_bf16 v[72:75], v[32:35], v[104:107], 0
    v_mfma_f32_16x16x32_bf16 v[76:79], v[32:35], v[108:111], 0
    v_mfma_f32_16x16x32_bf16 v[80:83], v[32:35], v[112:115], 0
    s_nop 0
    v_add_f32_dpp v24, v53, v52 row_ror:8 row_mask:0x1 bank_mask:0xf
    v_add_f32_dpp v25, v57, v56 row_ror:8 row_mask:0x1 bank_mask:0xf
    v_add_f32_dpp v24, v61, v60 row_ror:8 row_mask:0x2 bank_mask:0xf
    v_add_f32_dpp v25, v65, v64 row_ror:8 row_mask:0x2 bank_mask:0xf
    v_add_f32_dpp v24, v69, v68 row_ror:8 row_mask:0x4 bank_mask:0xf
    v_add_f32_dpp v25, v73, v72 row_ror:8 row_mask:0x4 bank_mask:0xf
    v_add_f32_dpp v24, v77, v76 row_ror:8 row_mask:0x8 bank_mask:0xf
    v_add_f32_dpp v25, v81, v80 row_ror:8 row_mask:0x8 bank_mask:0xf
    s_mov_b32 exec_lo, 0x00ff00ff
    s_mov_b32 exec_hi, 0x00ff00ff
    ds_write_b64 v9, v[24:25] offset:0
    s_mov_b64 exec, -1
    s_waitcnt lgkmcnt(0)
    s_barrier
    s_cmp_lg_u32 s3, 0
    s_cbranch_scc1 L_mod2skip
    s_lshl_b32 s31, s43, 8
    s_add_u32 s31, s31, 69632
    s_mov_b64 exec, 0xffff
    ds_read_b128 v[52:55], v4 offset:0
    ds_read_b128 v[56:59], v4 offset:256
    ds_read_b128 v[60:63], v4 offset:512
    ds_read_b128 v[64:67], v4 offset:768
    ds_read_b128 v[68:71], v4 offset:1024
    ds_read_b128 v[72:75], v4 offset:1280
    ds_read_b128 v[76:79], v4 offset:1536
    ds_read_b128 v[80:83], v4 offset:1792
    s_waitcnt lgkmcnt(0)
    v_pk_add_f32 v[52:53], v[52:53], v[68:69]
    v_pk_add_f32 v[56:57], v[56:57], v[72:73]
    v_pk_add_f32 v[60:61], v[60:61], v[76:77]
    v_pk_add_f32 v[64:65], v[64:65], v[80:81]
    v_pk_add_f32 v[52:53], v[52:53], v[60:61]
    v_pk_add_f32 v[56:57], v[56:57], v[64:65]
    v_pk_add_f32 v[52:53], v[52:53], v[56:57]
    v_pk_add_f32 v[54:55], v[54:55], v[70:71]
    v_pk_add_f32 v[58:59], v[58:59], v[74:75]
    v_pk_add_f32 v[62:63], v[62:63], v[78:79]
    v_pk_add_f32 v[66:67], v[66:67], v[82:83]
    v_pk_add_f32 v[54:55], v[54:55], v[62:63]
    v_pk_add_f32 v[58:59], v[58:59], v[66:67]
    v_pk_add_f32 v[54:55], v[54:55], v[58:59]
    v_cvt_pk_bf16_f32 v24, v52, v53
    v_cvt_pk_bf16_f32 v26, v54, v55
    v_mov_b32 v25, s39
    v_mov_b32 v27, s39
    buffer_store_dwordx4 v[24:27], v4, s[16:19], s31 offen sc1
    s_mov_b64 exec, -1
    s_nop 1
    s_getreg_b32 s31, hwreg(HW_REG_XCC_ID, 0, 3)
    v_mov_b32 v24, s31
    s_lshl_b32 s31, s43, 3
    s_add_u32 s31, s31, 98304
    s_mov_b64 exec, 1
    buffer_store_dwordx2 v[24:25], v12, s[16:19], s31 offen sc1
    s_mov_b64 exec, -1
L_mod2skip:
    s_add_u32 s28, s28, 32768
    s_add_u32 s30, s28, 0
    s_waitcnt vmcnt(15)
    buffer_load_dwordx4 v[212:215], v15, s[20:23], s30 offen nt
    s_add_u32 s30, s28, 4096
    s_waitcnt vmcnt(15)
    buffer_load_dwordx4 v[216:219], v15, s[20:23], s30 offen nt
    s_add_u32 s30, s28, 8192
    s_waitcnt vmcnt(15)
    buffer_load_dwordx4 v[220:223], v15, s[20:23], s30 offen nt
    s_add_u32 s30, s28, 12288
    s_waitcnt vmcnt(15)
    buffer_load_dwordx4 v[224:227], v15, s[20:23], s30 offen nt
    s_add_u32 s30, s28, 16384
    s_waitcnt vmcnt(15)
    buffer_load_dwordx4 v[228:231], v15, s[20:23], s30 offen nt
    s_add_u32 s30, s28, 20480
    s_waitcnt vmcnt(15)
    buffer_load_dwordx4 v[232:235], v15, s[20:23], s30 offen nt
    s_add_u32 s30, s28, 24576
    s_waitcnt vmcnt(15)
    buffer_load_dwordx4 v[236:239], v15, s[20:23], s30 offen nt
    s_add_u32 s30, s28, 28672
    s_waitcnt vmcnt(15)
    buffer_load_dwordx4 v[240:243], v15, s[20:23], s30 offen nt
    s_cmp_ge_u32 s43, 28
    s_cbranch_scc1 L_noffn1
    v_bfe_u32 v10, v1, 3, 1
    v_lshlrev_b32 v15, 13, v11
    v_and_b32 v13, 7, v1
    v_lshl_add_u32 v15, v13, 4, v15
    v_lshl_add_u32 v13, v10, 15, v15
    s_mov_b32 s46, 0xff00ff00
    s_mov_b32 s47, 0xff00ff00
    v_mov_b32 v36, s76
    v_mov_b32 v37, s77
    v_mov_b32 v10, s78
    v_mov_b32 v15, s79
    v_cndmask_b32 v36, v36, v10, s[46:47]
    v_cndmask_b32 v37, v37, v15, s[46:47]
    v_mul_u32_u24 v10, 28672, v11
    v_and_b32 v15, 7, v1
    v_lshl_add_u32 v10, v15, 4, v10
    s_mul_i32 s30, s3, 229376
    s_lshl_b32 s31, s43, 7
    s_add_u32 s30, s30, s31
    v_add_u32 v10, s30, v10
    v_add_co_u32 v36, vcc, v36, v10
    s_nop 1
    v_addc_co_u32 v37, vcc, 0, v37, vcc
    v_add_co_u32 v38, vcc, 0, v36
    s_waitcnt vmcnt(15)
    s_nop 0
    v_addc_co_u32 v39, vcc, 0, v37, vcc
    global_load_dwordx4 v[116:119], v[38:39], off nt
    v_add_co_u32 v38, vcc, 3584, v36
    s_waitcnt vmcnt(15)
    s_nop 0
    v_addc_co_u32 v39, vcc, 0, v37, vcc
    global_load_dwordx4 v[120:123], v[38:39], off nt
    v_add_co_u32 v38, vcc, 7168, v36
    s_waitcnt vmcnt(15)
    s_nop 0
    v_addc_co_u32 v39, vcc, 0, v37, vcc
    global_load_dwordx4 v[124:127], v[38:39], off nt
    v_add_co_u32 v38, vcc, 10752, v36
    s_waitcnt vmcnt(15)
    s_nop 0
    v_addc_co_u32 v39, vcc, 0, v37, vcc
    global_load_dwordx4 v[128:131], v[38:39], off nt
    v_add_co_u32 v38, vcc, 14336, v36
    s_waitcnt vmcnt(15)
    s_nop 0
    v_addc_co_u32 v39, vcc, 0, v37, vcc
    global_load_dwordx4 v[132:135], v[38:39], off nt
    v_add_co_u32 v38, vcc, 17920, v36
    s_waitcnt vmcnt(15)
    s_nop 0
    v_addc_co_u32 v39, vcc, 0, v37, vcc
    global_load_dwordx4 v[136:139], v[38:39], off nt
    v_add_co_u32 v38, vcc, 21504, v36
    s_waitcnt vmcnt(15)
    s_nop 0
    v_addc_co_u32 v39, vcc, 0, v37, vcc
    global_load_dwordx4 v[140:143], v[38:39], off nt
    v_add_co_u32 v38, vcc, 25088, v36
    s_waitcnt vmcnt(15)
    s_nop 0
    v_addc_co_u32 v39, vcc, 0, v37, vcc
    global_load_dwordx4 v[144:147], v[38:39], off nt
    v_add_co_u32 v38, vcc, 114688, v36
    s_waitcnt vmcnt(15)
    s_nop 0
    v_addc_co_u32 v39, vcc, 0, v37, vcc
    global_load_dwordx4 v[148:151], v[38:39], off nt
    v_add_co_u32 v38, vcc, 118272, v36
    s_waitcnt vmcnt(15)
    s_nop 0
    v_addc_co_u32 v39, vcc, 0, v37, vcc
    global_load_dwordx4 v[152:155], v[38:39], off nt
    v_add_co_u32 v38, vcc, 121856, v36
    s_waitcnt vmcnt(15)
    s_nop 0
    v_addc_co_u32 v39, vcc, 0, v37, vcc
    global_load_dwordx4 v[156:159], v[38:39], off nt
    v_add_co_u32 v38, vcc, 125440, v36
    s_waitcnt vmcnt(15)
    s_nop 0
    v_addc_co_u32 v39, vcc, 0, v37, vcc
    global_load_dwordx4 v[160:163], v[38:39], off nt
    v_add_co_u32 v38, vcc, 129024, v36
    s_waitcnt vmcnt(15)
    s_nop 0
    v_addc_co_u32 v39, vcc, 0, v37, vcc
    global_load_dwordx4 v[164:167], v[38:39], off nt
    v_add_co_u32 v38, vcc, 132608, v36
    s_waitcnt vmcnt(15)
    s_nop 0
    v_addc_co_u32 v39, vcc, 0, v37, vcc
    global_load_dwordx4 v[168:171], v[38:39], off nt
    v_add_co_u32 v38, vcc, 136192, v36
    s_waitcnt vmcnt(15)
    s_nop 0
    v_addc_co_u32 v39, vcc, 0, v37, vcc
    global_load_dwordx4 v[172:175], v[38:39], off nt
    v_add_co_u32 v38, vcc, 139776, v36
    s_waitcnt vmcnt(15)
    s_nop 0
    v_addc_co_u32 v39, vcc, 0, v37, vcc
    global_load_dwordx4 v[176:179], v[38:39], off nt
    s_lshl_b32 s28, s43, 16
    s_lshl_b32 s31, s3, 7
    s_add_u32 s28, s28, s31
    s_add_u32 s30, s28, 0
    s_waitcnt vmcnt(15)
    buffer_load_dwordx4 v[84:87], v13, s[24:27], s30 offen nt
    s_add_u32 s30, s28, 1024
    s_waitcnt vmcnt(15)
    buffer_load_dwordx4 v[88:91], v13, s[24:27], s30 offen nt
    s_add_u32 s30, s28, 2048
    s_waitcnt vmcnt(15)
    buffer_load_dwordx4 v[92:95], v13, s[24:27], s30 offen nt
    s_add_u32 s30, s28, 3072
    s_waitcnt vmcnt(15)
    buffer_load_dwordx4 v[96:99], v13, s[24:27], s30 offen nt
    s_add_u32 s30, s28, 4096
    s_waitcnt vmcnt(15)
    buffer_load_dwordx4 v[100:103], v13, s[24:27], s30 offen nt
    s_add_u32 s30, s28, 5120
    s_waitcnt vmcnt(15)
    buffer_load_dwordx4 v[104:107], v13, s[24:27], s30 offen nt
    s_add_u32 s30, s28, 6144
    s_waitcnt vmcnt(15)
    buffer_load_dwordx4 v[108:111], v13, s[24:27], s30 offen nt
    s_add_u32 s30, s28, 7168
    s_waitcnt vmcnt(15)
    buffer_load_dwordx4 v[112:115], v13, s[24:27], s30 offen nt
    s_waitcnt vmcnt(24)
    s_branch L_ffn1j
L_noffn1:
    s_waitcnt vmcnt(0)
L_ffn1j:
    s_lshl_b32 s30, s3, 14
    s_add_u32 s30, s30, 24576
    v_add_u32 v10, s30, v4
    ds_write_b128 v10, v[180:183] offset:0
    ds_write_b128 v10, v[184:187] offset:1024
    ds_write_b128 v10, v[188:191] offset:2048
    ds_write_b128 v10, v[192:195] offset:3072
    ds_write_b128 v10, v[196:199] offset:4096
    ds_write_b128 v10, v[200:203] offset:5120
    ds_write_b128 v10, v[204:207] offset:6144
    ds_write_b128 v10, v[208:211] offset:7168
    ds_write_b128 v10, v[212:215] offset:8192
    ds_write_b128 v10, v[216:219] offset:9216
    ds_write_b128 v10, v[220:223] offset:10240
    ds_write_b128 v10, v[224:227] offset:11264
    ds_write_b128 v10, v[228:231] offset:12288
    ds_write_b128 v10, v[232:235] offset:13312
    ds_write_b128 v10, v[236:239] offset:14336
    ds_write_b128 v10, v[240:243] offset:15360
    v_lshrrev_b32 v15, 1, v2
    v_lshlrev_b32 v15, 3, v15
    v_lshrrev_b32 v13, 1, v3
    v_lshlrev_b32 v13, 3, v13
    s_mov_b32 s49, 69632
    s_mov_b32 s50, 73728
    s_lshl_b32 s51, s41, 11
    s_add_u32 s51, s51, 81920
    v_and_b32 v10, 3, v1
    v_lshlrev_b32 v245, 9, v10
    v_lshl_add_u32 v245, v11, 7, v245
    v_bfe_u32 v10, v1, 2, 2
    v_lshl_add_u32 v245, v10, 5, v245
    v_and_b32 v246, 31, v1
    v_lshlrev_b32 v246, 3, v246
    v_add_u32 v246, 98304, v246
    buffer_load_dwordx2 v[30:31], v246, s[16:19], 0 offen sc1
    buffer_load_dwordx2 v[36:37], v15, s[16:19], s49 offen sc1
    buffer_load_dwordx2 v[38:39], v15, s[16:19], s49 offen offset:2048 sc1
    buffer_load_dwordx2 v[40:41], v15, s[16:19], s50 offen sc1
    buffer_load_dwordx2 v[42:43], v15, s[16:19], s50 offen offset:2048 sc1
    buffer_load_dwordx2 v[24:25], v13, s[16:19], s50 offen offset:2048 sc1
    buffer_load_dwordx4 v[248:251], v245, s[16:19], s51 offen sc1
    buffer_load_dwordx4 v[252:255], v245, s[16:19], s51 offen offset:16 sc1
    v_and_b32 v9, 63, v2
    v_and_b32 v11, 12, v9
    v_and_b32 v7, -15, v9
    v_lshl_add_u32 v7, v7, 1, v11
    v_and_b32 v11, 2, v9
    v_lshl_add_u32 v7, v11, 3, v7
    s_lshl_b32 s30, s3, 8
    v_add_u32 v7, s30, v7
    v_and_b32 v9, 1, v1
    v_lshlrev_b32 v9, 7, v9
    v_and_b32 v11, 2, v1
    v_lshl_add_u32 v9, v11, 3, v9
    v_lshrrev_b32 v11, 4, v1
    v_lshl_add_u32 v9, v11, 5, v9
    v_add_u32 v9, s30, v9
    s_add_u32 s42, s38, 28
    s_mul_i32 s38, s41, 136
    s_lshl_b32 s29, s41, 24
    v_bfe_u32 v2, v1, 2, 2
    v_lshlrev_b32 v2, 8, v2
    v_lshrrev_b32 v10, 4, v1
    v_lshl_add_u32 v2, v10, 6, v2
    v_and_b32 v11, 3, v1
    v_lshl_add_u32 v2, v11, 4, v2
    v_add_u32 v3, 4096, v2
    v_add_u32 v5, 4096, v4
    s_mov_b32 s8, s66
    s_mov_b32 s9, s67
    s_mov_b32 s10, 0x8000000
    s_mov_b32 s11, 0x00020000
    s_mov_b32 s12, s68
    s_mov_b32 s13, s69
    s_mov_b32 s14, 0x8000000
    s_mov_b32 s15, 0x00020000
    s_lshl_b32 s30, s42, 2
    s_add_u32 s30, s30, s3
    s_add_u32 s30, s30, 1432
    s_add_u32 s30, s30, s38
    s_and_b32 s30, s30, 2047
    s_lshl_b32 s30, s30, 13
    s_add_u32 s28, s29, s30
    s_waitcnt vmcnt(16) lgkmcnt(0)
    v_perm_b32 v180, v120, v116, s32
    v_perm_b32 v181, v128, v124, s32
    v_perm_b32 v182, v136, v132, s32
    v_perm_b32 v183, v144, v140, s32
    v_perm_b32 v188, v120, v116, s33
    v_perm_b32 v189, v128, v124, s33
    v_perm_b32 v190, v136, v132, s33
    v_perm_b32 v191, v144, v140, s33
    v_perm_b32 v196, v121, v117, s32
    v_perm_b32 v197, v129, v125, s32
    v_perm_b32 v198, v137, v133, s32
    v_perm_b32 v199, v145, v141, s32
    v_perm_b32 v204, v121, v117, s33
    v_perm_b32 v205, v129, v125, s33
    v_perm_b32 v206, v137, v133, s33
    v_perm_b32 v207, v145, v141, s33
    v_perm_b32 v212, v122, v118, s32
    v_perm_b32 v213, v130, v126, s32
    v_perm_b32 v214, v138, v134, s32
    v_perm_b32 v215, v146, v142, s32
    v_perm_b32 v220, v122, v118, s33
    v_perm_b32 v221, v130, v126, s33
    v_perm_b32 v222, v138, v134, s33
    v_perm_b32 v223, v146, v142, s33
    v_perm_b32 v228, v123, v119, s32
    v_perm_b32 v229, v131, v127, s32
    v_perm_b32 v230, v139, v135, s32
    v_perm_b32 v231, v147, v143, s32
    v_perm_b32 v236, v123, v119, s33
    v_perm_b32 v237, v131, v127, s33
    v_perm_b32 v238, v139, v135, s33
    v_perm_b32 v239, v147, v143, s33
    v_perm_b32 v184, v152, v148, s32
    v_perm_b32 v185, v160, v156, s32
    v_perm_b32 v186, v168, v164, s32
    v_perm_b32 v187, v176, v172, s32
    v_perm_b32 v192, v152, v148, s33
    v_perm_b32 v193, v160, v156, s33
    v_perm_b32 v194, v168, v164, s33
    v_perm_b32 v195, v176, v172, s33
    v_perm_b32 v200, v153, v149, s32
    v_perm_b32 v201, v161, v157, s32
    v_perm_b32 v202, v169, v165, s32
    v_perm_b32 v203, v177, v173, s32
    v_perm_b32 v208, v153, v149, s33
    v_perm_b32 v209, v161, v157, s33
    v_perm_b32 v210, v169, v165, s33
    v_perm_b32 v211, v177, v173, s33
    v_perm_b32 v216, v154, v150, s32
    v_perm_b32 v217, v162, v158, s32
    v_perm_b32 v218, v170, v166, s32
    v_perm_b32 v219, v178, v174, s32
    v_perm_b32 v224, v154, v150, s33
    v_perm_b32 v225, v162, v158, s33
    v_perm_b32 v226, v170, v166, s33
    v_perm_b32 v227, v178, v174, s33
    v_perm_b32 v232, v155, v151, s32
    v_perm_b32 v233, v163, v159, s32
    v_perm_b32 v234, v171, v167, s32
    v_perm_b32 v235, v179, v175, s32
    v_perm_b32 v240, v155, v151, s33
    v_perm_b32 v241, v163, v159, s33
    v_perm_b32 v242, v171, v167, s33
    v_perm_b32 v243, v179, v175, s33
    s_mov_b32 s40, 65536
    s_cmp_ge_u32 s3, 4
    s_cbranch_scc1 L_frag
    buffer_load_dwordx4 v[116:119], v2, s[8:11], s28 offen offset:0 nt
    buffer_load_dwordx4 v[120:123], v2, s[8:11], s28 offen offset:1024 nt
    buffer_load_dwordx4 v[124:127], v2, s[8:11], s28 offen offset:2048 nt
    buffer_load_dwordx4 v[128:131], v2, s[8:11], s28 offen offset:3072 nt
    buffer_load_dwordx4 v[132:135], v3, s[8:11], s28 offen offset:0 nt
    buffer_load_dwordx4 v[136:139], v3, s[8:11], s28 offen offset:1024 nt
    buffer_load_dwordx4 v[140:143], v3, s[8:11], s28 offen offset:2048 nt
    buffer_load_dwordx4 v[144:147], v3, s[8:11], s28 offen offset:3072 nt
    buffer_load_dwordx4 v[148:151], v4, s[12:15], s28 offen offset:0 nt
    buffer_load_dwordx4 v[152:155], v4, s[12:15], s28 offen offset:1024 nt
    buffer_load_dwordx4 v[156:159], v4, s[12:15], s28 offen offset:2048 nt
    buffer_load_dwordx4 v[160:163], v4, s[12:15], s28 offen offset:3072 nt
    buffer_load_dwordx4 v[164:167], v5, s[12:15], s28 offen offset:0 nt
    buffer_load_dwordx4 v[168:171], v5, s[12:15], s28 offen offset:1024 nt
    buffer_load_dwordx4 v[172:175], v5, s[12:15], s28 offen offset:2048 nt
    buffer_load_dwordx4 v[176:179], v5, s[12:15], s28 offen offset:3072 nt
    s_waitcnt vmcnt(24)
    v_perm_b32 v52, v88, v84, s32
    v_perm_b32 v53, v96, v92, s32
    v_perm_b32 v54, v104, v100, s32
    v_perm_b32 v55, v112, v108, s32
    v_perm_b32 v60, v88, v84, s33
    v_perm_b32 v61, v96, v92, s33
    v_perm_b32 v62, v104, v100, s33
    v_perm_b32 v63, v112, v108, s33
    v_perm_b32 v68, v89, v85, s32
    v_perm_b32 v69, v97, v93, s32
    v_perm_b32 v70, v105, v101, s32
    v_perm_b32 v71, v113, v109, s32
    v_perm_b32 v76, v89, v85, s33
    v_perm_b32 v77, v97, v93, s33
    v_perm_b32 v78, v105, v101, s33
    v_perm_b32 v79, v113, v109, s33
    v_perm_b32 v56, v90, v86, s32
    v_perm_b32 v57, v98, v94, s32
    v_perm_b32 v58, v106, v102, s32
    v_perm_b32 v59, v114, v110, s32
    v_perm_b32 v64, v90, v86, s33
    v_perm_b32 v65, v98, v94, s33
    v_perm_b32 v66, v106, v102, s33
    v_perm_b32 v67, v114, v110, s33
    v_perm_b32 v72, v91, v87, s32
    v_perm_b32 v73, v99, v95, s32
    v_perm_b32 v74, v107, v103, s32
    v_perm_b32 v75, v115, v111, s32
    v_perm_b32 v80, v91, v87, s33
    v_perm_b32 v81, v99, v95, s33
    v_perm_b32 v82, v107, v103, s33
    v_perm_b32 v83, v115, v111, s33
    s_barrier
    s_waitcnt vmcnt(16)
    s_branch L_poll2d
L_frag:
    s_waitcnt vmcnt(8)
    v_perm_b32 v52, v88, v84, s32
    v_perm_b32 v53, v96, v92, s32
    v_perm_b32 v54, v104, v100, s32
    v_perm_b32 v55, v112, v108, s32
    v_perm_b32 v60, v88, v84, s33
    v_perm_b32 v61, v96, v92, s33
    v_perm_b32 v62, v104, v100, s33
    v_perm_b32 v63, v112, v108, s33
    v_perm_b32 v68, v89, v85, s32
    v_perm_b32 v69, v97, v93, s32
    v_perm_b32 v70, v105, v101, s32
    v_perm_b32 v71, v113, v109, s32
    v_perm_b32 v76, v89, v85, s33
    v_perm_b32 v77, v97, v93, s33
    v_perm_b32 v78, v105, v101, s33
    v_perm_b32 v79, v113, v109, s33
    v_perm_b32 v56, v90, v86, s32
    v_perm_b32 v57, v98, v94, s32
    v_perm_b32 v58, v106, v102, s32
    v_perm_b32 v59, v114, v110, s32
    v_perm_b32 v64, v90, v86, s33
    v_perm_b32 v65, v98, v94, s33
    v_perm_b32 v66, v106, v102, s33
    v_perm_b32 v67, v114, v110, s33
    v_perm_b32 v72, v91, v87, s32
    v_perm_b32 v73, v99, v95, s32
    v_perm_b32 v74, v107, v103, s32
    v_perm_b32 v75, v115, v111, s32
    v_perm_b32 v80, v91, v87, s33
    v_perm_b32 v81, v99, v95, s33
    v_perm_b32 v82, v107, v103, s33
    v_perm_b32 v83, v115, v111, s33
    s_barrier
    v_bfe_u32 v10, v1, 3, 1
    v_lshlrev_b32 v10, 16, v10
    v_lshrrev_b32 v11, 4, v1
    v_lshl_add_u32 v10, v11, 11, v10
    v_and_b32 v244, 7, v1
    v_lshl_add_u32 v10, v244, 2, v10
    s_lshl_b32 s30, s3, 5
    s_add_u32 s30, s30, 24576
    v_add_u32 v10, s30, v10
    ds_read2st64_b32 v[84:85], v10 offset0:0 offset1:1
    ds_read2st64_b32 v[86:87], v10 offset0:2 offset1:3
    ds_read2st64_b32 v[88:89], v10 offset0:4 offset1:5
    ds_read2st64_b32 v[90:91], v10 offset0:6 offset1:7
    ds_read2st64_b32 v[92:93], v10 offset0:32 offset1:33
    ds_read2st64_b32 v[94:95], v10 offset0:34 offset1:35
    ds_read2st64_b32 v[96:97], v10 offset0:36 offset1:37
    ds_read2st64_b32 v[98:99], v10 offset0:38 offset1:39
    s_waitcnt lgkmcnt(0)
    ds_read2st64_b32 v[100:101], v10 offset0:64 offset1:65
    ds_read2st64_b32 v[102:103], v10 offset0:66 offset1:67
    ds_read2st64_b32 v[104:105], v10 offset0:68 offset1:69
    ds_read2st64_b32 v[106:107], v10 offset0:70 offset1:71
    ds_read2st64_b32 v[108:109], v10 offset0:96 offset1:97
    ds_read2st64_b32 v[110:111], v10 offset0:98 offset1:99
    ds_read2st64_b32 v[112:113], v10 offset0:100 offset1:101
    ds_read2st64_b32 v[114:115], v10 offset0:102 offset1:103
    v_perm_b32 v116, v85, v84, s32
    v_perm_b32 v117, v87, v86, s32
    v_perm_b32 v118, v89, v88, s32
    v_perm_b32 v119, v91, v90, s32
    v_perm_b32 v124, v85, v84, s33
    v_perm_b32 v125, v87, v86, s33
    v_perm_b32 v126, v89, v88, s33
    v_perm_b32 v127, v91, v90, s33
    v_perm_b32 v120, v93, v92, s32
    v_perm_b32 v121, v95, v94, s32
    v_perm_b32 v122, v97, v96, s32
    v_perm_b32 v123, v99, v98, s32
    v_perm_b32 v128, v93, v92, s33
    v_perm_b32 v129, v95, v94, s33
    v_perm_b32 v130, v97, v96, s33
    v_perm_b32 v131, v99, v98, s33
    s_waitcnt lgkmcnt(0)
    ds_read2st64_b32 v[84:85], v10 offset0:128 offset1:129
    ds_read2st64_b32 v[86:87], v10 offset0:130 offset1:131
    ds_read2st64_b32 v[88:89], v10 offset0:132 offset1:133
    ds_read2st64_b32 v[90:91], v10 offset0:134 offset1:135
    ds_read2st64_b32 v[92:93], v10 offset0:160 offset1:161
    ds_read2st64_b32 v[94:95], v10 offset0:162 offset1:163
    ds_read2st64_b32 v[96:97], v10 offset0:164 offset1:165
    ds_read2st64_b32 v[98:99], v10 offset0:166 offset1:167
    v_perm_b32 v132, v101, v100, s32
    v_perm_b32 v133, v103, v102, s32
    v_perm_b32 v134, v105, v104, s32
    v_perm_b32 v135, v107, v106, s32
    v_perm_b32 v140, v101, v100, s33
    v_perm_b32 v141, v103, v102, s33
    v_perm_b32 v142, v105, v104, s33
    v_perm_b32 v143, v107, v106, s33
    v_perm_b32 v136, v109, v108, s32
    v_perm_b32 v137, v111, v110, s32
    v_perm_b32 v138, v113, v112, s32
    v_perm_b32 v139, v115, v114, s32
    v_perm_b32 v144, v109, v108, s33
    v_perm_b32 v145, v111, v110, s33
    v_perm_b32 v146, v113, v112, s33
    v_perm_b32 v147, v115, v114, s33
    s_waitcnt lgkmcnt(0)
    ds_read2st64_b32 v[100:101], v10 offset0:192 offset1:193
    ds_read2st64_b32 v[102:103], v10 offset0:194 offset1:195
    ds_read2st64_b32 v[104:105], v10 offset0:196 offset1:197
    ds_read2st64_b32 v[106:107], v10 offset0:198 offset1:199
    ds_read2st64_b32 v[108:109], v10 offset0:224 offset1:225
    ds_read2st64_b32 v[110:111], v10 offset0:226 offset1:227
    ds_read2st64_b32 v[112:113], v10 offset0:228 offset1:229
    ds_read2st64_b32 v[114:115], v10 offset0:230 offset1:231
    v_perm_b32 v148, v85, v84, s32
    v_perm_b32 v149, v87, v86, s32
    v_perm_b32 v150, v89, v88, s32
    v_perm_b32 v151, v91, v90, s32
    v_perm_b32 v156, v85, v84, s33
    v_perm_b32 v157, v87, v86, s33
    v_perm_b32 v158, v89, v88, s33
    v_perm_b32 v159, v91, v90, s33
    v_perm_b32 v152, v93, v92, s32
    v_perm_b32 v153, v95, v94, s32
    v_perm_b32 v154, v97, v96, s32
    v_perm_b32 v155, v99, v98, s32
    v_perm_b32 v160, v93, v92, s33
    v_perm_b32 v161, v95, v94, s33
    v_perm_b32 v162, v97, v96, s33
    v_perm_b32 v163, v99, v98, s33
    s_waitcnt lgkmcnt(0)
    v_perm_b32 v164, v101, v100, s32
    v_perm_b32 v165, v103, v102, s32
    v_perm_b32 v166, v105, v104, s32
    v_perm_b32 v167, v107, v106, s32
    v_perm_b32 v172, v101, v100, s33
    v_perm_b32 v173, v103, v102, s33
    v_perm_b32 v174, v105, v104, s33
    v_perm_b32 v175, v107, v106, s33
    v_perm_b32 v168, v109, v108, s32
    v_perm_b32 v169, v111, v110, s32
    v_perm_b32 v170, v113, v112, s32
    v_perm_b32 v171, v115, v114, s32
    v_perm_b32 v176, v109, v108, s33
    v_perm_b32 v177, v111, v110, s33
    v_perm_b32 v178, v113, v112, s33
    v_perm_b32 v179, v115, v114, s33
    s_branch L_poll2c
L_poll2:
    buffer_load_dwordx2 v[30:31], v246, s[16:19], 0 offen sc1
    buffer_load_dwordx2 v[36:37], v15, s[16:19], s49 offen sc1
    buffer_load_dwordx2 v[38:39], v15, s[16:19], s49 offen offset:2048 sc1
    buffer_load_dwordx2 v[40:41], v15, s[16:19], s50 offen sc1
    buffer_load_dwordx2 v[42:43], v15, s[16:19], s50 offen offset:2048 sc1
    buffer_load_dwordx2 v[24:25], v13, s[16:19], s50 offen offset:2048 sc1
    buffer_load_dwordx4 v[248:251], v245, s[16:19], s51 offen sc1
    buffer_load_dwordx4 v[252:255], v245, s[16:19], s51 offen offset:16 sc1
L_poll2c:
    s_waitcnt vmcnt(0)
L_poll2d:
    v_xor_b32 v10, s39, v37
    v_xor_b32 v11, s39, v39
    v_or_b32 v10, v10, v11
    v_xor_b32 v11, s39, v41
    v_or_b32 v10, v10, v11
    v_xor_b32 v11, s39, v43
    v_or_b32 v10, v10, v11
    v_xor_b32 v11, s39, v25
    v_or_b32 v10, v10, v11
    v_xor_b32 v11, s39, v31
    v_or_b32 v10, v10, v11
    v_xor_b32 v11, s39, v249
    v_or_b32 v10, v10, v11
    v_xor_b32 v11, s39, v251
    v_or_b32 v10, v10, v11
    v_xor_b32 v11, s39, v253
    v_or_b32 v10, v10, v11
    v_xor_b32 v11, s39, v255
    v_or_b32 v10, v10, v11
    v_cmp_ne_u32 vcc, 0, v10
    s_cbranch_vccz L_poll2ok
    s_sleep 8
    s_sub_u32 s40, s40, 1
    s_cmp_lg_u32 s40, 0
    s_cbranch_scc1 L_poll2
L_poll2ok:
    s_getreg_b32 s31, hwreg(HW_REG_XCC_ID, 0, 3)
    v_cmp_ne_u32 vcc, s31, v30
    s_lshl_b32 s31, s31, 14
    s_add_u32 s31, s31, s36
    s_or_b32 s0, vcc_lo, vcc_hi
    s_cselect_b32 s5, s5, s31
    s_mov_b32 s44, 0
    s_mov_b32 s45, -1
    v_lshlrev_b32 v10, 16, v36
    v_and_b32 v45, 0xffff0000, v36
    v_cndmask_b32 v45, v10, v45, s[44:45]
    v_lshlrev_b32 v10, 16, v38
    v_and_b32 v26, 0xffff0000, v38
    v_cndmask_b32 v26, v10, v26, s[44:45]
    v_lshlrev_b32 v10, 16, v40
    v_and_b32 v46, 0xffff0000, v40
    v_cndmask_b32 v46, v10, v46, s[44:45]
    v_lshlrev_b32 v10, 16, v24
    v_and_b32 v47, 0xffff0000, v24
    v_cndmask_b32 v47, v10, v47, s[44:45]
    v_add_f32 v46, 1.0, v46
    v_cvt_pk_bf16_f32 v46, v46, v46
    v_and_b32 v46, 0xffff0000, v46
    s_cmp_ge_u32 s43, 28
    s_cbranch_scc1 L_nopre
    ds_write_b16_d16_hi v7, v46 offset:8192
    ds_write_b16_d16_hi v7, v26 offset:8320
    s_waitcnt lgkmcnt(0)
    ds_read_b128 v[16:19], v9 offset:8192
    v_bfe_u32 v32, v1, 1, 1
    v_mul_u32_u24 v32, 0xaaaa, v32
    v_add_u32 v32, 0x4444, v32
    v_mov_b32 v84, 0
    v_mov_b32 v85, 0
    v_mov_b32 v86, 0
    v_mov_b32 v87, 0
    v_mov_b32 v88, 0
    v_mov_b32 v89, 0
    v_mov_b32 v90, 0
    v_mov_b32 v91, 0
    v_mov_b32 v92, 0
    v_mov_b32 v93, 0
    v_mov_b32 v94, 0
    v_mov_b32 v95, 0
    v_mov_b32 v96, 0
    v_mov_b32 v97, 0
    v_mov_b32 v98, 0
    v_mov_b32 v99, 0
    v_mov_b32 v100, 0
    v_mov_b32 v101, 0
    v_mov_b32 v102, 0
    v_mov_b32 v103, 0
    v_mov_b32 v104, 0
    v_mov_b32 v105, 0
    v_mov_b32 v106, 0
    v_mov_b32 v107, 0
    v_mov_b32 v108, 0
    v_mov_b32 v109, 0
    v_mov_b32 v110, 0
    v_mov_b32 v111, 0
    v_mov_b32 v112, 0
    v_mov_b32 v113, 0
    v_mov_b32 v114, 0
    v_mov_b32 v115, 0
    s_waitcnt lgkmcnt(0)
    s_nop 1
    v_smfmac_f32_16x16x64_bf16 v[84:87], v[16:19], v[180:187], v32
    v_smfmac_f32_16x16x64_bf16 v[88:91], v[16:19], v[188:195], v32
    v_smfmac_f32_16x16x64_bf16 v[92:95], v[16:19], v[196:203], v32
    v_smfmac_f32_16x16x64_bf16 v[96:99], v[16:19], v[204:211], v32
    v_smfmac_f32_16x16x64_bf16 v[100:103], v[16:19], v[212:219], v32
    v_smfmac_f32_16x16x64_bf16 v[104:107], v[16:19], v[220:227], v32
    v_smfmac_f32_16x16x64_bf16 v[108:111], v[16:19], v[228:235], v32
    v_smfmac_f32_16x16x64_bf16 v[112:115], v[16:19], v[236:243], v32
    s_nop 7
    v_pk_add_f32 v[84:85], v[84:85], v[86:87]
    v_pk_add_f32 v[88:89], v[88:89], v[90:91]
    v_pk_add_f32 v[92:93], v[92:93], v[94:95]
    v_pk_add_f32 v[96:97], v[96:97], v[98:99]
    v_pk_add_f32 v[100:101], v[100:101], v[102:103]
    v_pk_add_f32 v[104:105], v[104:105], v[106:107]
    v_pk_add_f32 v[108:109], v[108:109], v[110:111]
    v_pk_add_f32 v[112:113], v[112:113], v[114:115]
    s_nop 1
    v_mov_b32_dpp v24, v84 quad_perm:[0,1,2,3] row_mask:0x1 bank_mask:0xf
    v_mov_b32_dpp v26, v85 quad_perm:[0,1,2,3] row_mask:0x1 bank_mask:0xf
    v_mov_b32_dpp v25, v88 quad_perm:[0,1,2,3] row_mask:0x1 bank_mask:0xf
    v_mov_b32_dpp v27, v89 quad_perm:[0,1,2,3] row_mask:0x1 bank_mask:0xf
    v_mov_b32_dpp v24, v92 quad_perm:[0,1,2,3] row_mask:0x2 bank_mask:0xf
    v_mov_b32_dpp v26, v93 quad_perm:[0,1,2,3] row_mask:0x2 bank_mask:0xf
    v_mov_b32_dpp v25, v96 quad_perm:[0,1,2,3] row_mask:0x2 bank_mask:0xf
    v_mov_b32_dpp v27, v97 quad_perm:[0,1,2,3] row_mask:0x2 bank_mask:0xf
    v_mov_b32_dpp v24, v100 quad_perm:[0,1,2,3] row_mask:0x4 bank_mask:0xf
    v_mov_b32_dpp v26, v101 quad_perm:[0,1,2,3] row_mask:0x4 bank_mask:0xf
    v_mov_b32_dpp v25, v104 quad_perm:[0,1,2,3] row_mask:0x4 bank_mask:0xf
    v_mov_b32_dpp v27, v105 quad_perm:[0,1,2,3] row_mask:0x4 bank_mask:0xf
    v_mov_b32_dpp v24, v108 quad_perm:[0,1,2,3] row_mask:0x8 bank_mask:0xf
    v_mov_b32_dpp v26, v109 quad_perm:[0,1,2,3] row_mask:0x8 bank_mask:0xf
    v_mov_b32_dpp v25, v112 quad_perm:[0,1,2,3] row_mask:0x8 bank_mask:0xf
    v_mov_b32_dpp v27, v113 quad_perm:[0,1,2,3] row_mask:0x8 bank_mask:0xf
    ds_write_b64 v8, v[24:25] offset:10240
    ds_write_b64 v8, v[26:27] offset:14336
    s_waitcnt lgkmcnt(0)
    s_barrier
    v_and_b32 v10, 7, v1
    v_lshrrev_b32 v11, 3, v1
    v_lshl_add_u32 v10, v10, 3, v11
    v_lshlrev_b32 v10, 2, v10
    ds_read2st64_b32 v[84:85], v10 offset0:40 offset1:41
    ds_read2st64_b32 v[100:101], v10 offset0:56 offset1:57
    ds_read2st64_b32 v[86:87], v10 offset0:42 offset1:43
    ds_read2st64_b32 v[102:103], v10 offset0:58 offset1:59
    ds_read2st64_b32 v[88:89], v10 offset0:44 offset1:45
    ds_read2st64_b32 v[104:105], v10 offset0:60 offset1:61
    ds_read2st64_b32 v[90:91], v10 offset0:46 offset1:47
    ds_read2st64_b32 v[106:107], v10 offset0:62 offset1:63
    ds_read2st64_b32 v[92:93], v10 offset0:48 offset1:49
    ds_read2st64_b32 v[108:109], v10 offset0:64 offset1:65
    ds_read2st64_b32 v[94:95], v10 offset0:50 offset1:51
    ds_read2st64_b32 v[110:111], v10 offset0:66 offset1:67
    ds_read2st64_b32 v[96:97], v10 offset0:52 offset1:53
    ds_read2st64_b32 v[112:113], v10 offset0:68 offset1:69
    ds_read2st64_b32 v[98:99], v10 offset0:54 offset1:55
    ds_read2st64_b32 v[114:115], v10 offset0:70 offset1:71
    s_waitcnt lgkmcnt(0)
    v_pk_add_f32 v[84:85], v[84:85], v[92:93]
    v_pk_add_f32 v[86:87], v[86:87], v[94:95]
    v_pk_add_f32 v[88:89], v[88:89], v[96:97]
    v_pk_add_f32 v[90:91], v[90:91], v[98:99]
    v_pk_add_f32 v[84:85], v[84:85], v[88:89]
    v_pk_add_f32 v[86:87], v[86:87], v[90:91]
    v_pk_add_f32 v[84:85], v[84:85], v[86:87]
    v_pk_add_f32 v[100:101], v[100:101], v[108:109]
    v_pk_add_f32 v[102:103], v[102:103], v[110:111]
    v_pk_add_f32 v[104:105], v[104:105], v[112:113]
    v_pk_add_f32 v[106:107], v[106:107], v[114:115]
    v_pk_add_f32 v[100:101], v[100:101], v[104:105]
    v_pk_add_f32 v[102:103], v[102:103], v[106:107]
    v_pk_add_f32 v[100:101], v[100:101], v[102:103]
    v_mov_b32 v48, v84
    v_mov_b32 v49, v85
    v_mov_b32 v50, v100
    v_mov_b32 v51, v101
L_nopre:
    s_cmp_lg_u32 s3, 7
    s_cbranch_scc1 L_sv1
    ds_write_b128 v4, v[248:251] offset:20992
    ds_write_b128 v4, v[252:255] offset:22016
    s_waitcnt lgkmcnt(0)
L_sv1:
    v_lshrrev_b32 v15, 3, v1
    v_lshlrev_b32 v15, 8, v15
    v_and_b32 v10, 7, v1
    v_lshl_add_u32 v15, v10, 4, v15
    s_lshl_b32 s30, s3, 14
    s_add_u32 s30, s30, 24704
    v_add_u32 v15, s30, v15
    s_barrier
    s_cmp_ge_u32 s3, 4
    s_cbranch_scc1 L_qwait
    ds_write_b128 v15, v[52:55] offset:0
    ds_write_b128 v15, v[56:59] offset:2048
    ds_write_b128 v15, v[60:63] offset:4096
    ds_write_b128 v15, v[64:67] offset:6144
    ds_write_b128 v15, v[68:71] offset:8192
    ds_write_b128 v15, v[72:75] offset:10240
    ds_write_b128 v15, v[76:79] offset:12288
    ds_write_b128 v15, v[80:83] offset:14336
    s_branch L_qwait
L_service2:
    s_setprio 0
    s_and_b32 s41, s43, 7
    s_lshr_b32 s38, s43, 3
    v_lshrrev_b32 v11, 4, v1
    v_lshrrev_b32 v10, 5, v1
    v_and_b32 v8, 1, v11
    v_lshl_add_u32 v8, v8, 1, v10
    v_and_b32 v10, 15, v1
    v_lshl_add_u32 v2, v10, 2, v8
    s_lshl_b32 s30, s3, 6
    v_add_u32 v2, s30, v2
    v_and_b32 v10, 3, v1
    v_lshl_add_u32 v3, v10, 2, v8
    s_lshl_b32 s30, s43, 4
    v_add_u32 v3, s30, v3
    v_and_b32 v10, 1, v1
    v_lshlrev_b32 v10, 6, v10
    v_lshl_add_u32 v13, v11, 4, v10
    v_bfe_u32 v15, v1, 3, 1
    v_lshl_add_u32 v15, v15, 2, v11
    v_mul_u32_u24 v7, 49152, v15
    v_and_b32 v10, 7, v1
    v_lshl_add_u32 v7, v10, 4, v7
    s_mul_i32 s29, s3, 393216
    v_and_b32 v10, 3, v1
    v_lshlrev_b32 v10, 4, v10
    v_lshl_add_u32 v5, v11, 14, v10
    s_lshl_b32 s36, s41, 11
    s_lshl_b32 s31, s38, 9
    s_add_u32 s36, s36, s31
    s_lshl_b32 s31, s3, 6
    s_add_u32 s36, s36, s31
    s_add_u32 s36, s36, 1048576
    s_add_u32 s5, s36, 0x10000
    v_bfe_u32 v10, v1, 1, 2
    v_lshlrev_b32 v14, 11, v10
    v_and_b32 v10, 1, v1
    v_lshl_add_u32 v14, v10, 5, v14
    v_lshl_add_u32 v14, v11, 4, v14
    s_lshl_b32 s37, s3, 13
    s_lshl_b32 s31, s43, 6
    s_add_u32 s37, s37, s31
    s_add_u32 s37, s37, 131072
    v_and_b32 v8, 15, v1
    v_lshlrev_b32 v8, 5, v8
    v_lshl_add_u32 v8, v11, 3, v8
    s_lshl_b32 s30, s3, 9
    v_add_u32 v8, s30, v8
    v_and_b32 v9, 63, v2
    v_and_b32 v11, 12, v9
    v_and_b32 v7, -15, v9
    v_lshl_add_u32 v7, v7, 1, v11
    v_and_b32 v11, 2, v9
    v_lshl_add_u32 v7, v11, 3, v7
    s_lshl_b32 s30, s3, 8
    v_add_u32 v7, s30, v7
    v_and_b32 v9, 1, v1
    v_lshlrev_b32 v9, 7, v9
    v_and_b32 v11, 2, v1
    v_lshl_add_u32 v9, v11, 3, v9
    v_lshrrev_b32 v11, 4, v1
    v_lshl_add_u32 v9, v11, 5, v9
    v_add_u32 v9, s30, v9
    s_mov_b32 s20, s86
    s_mov_b32 s21, s87
    s_mov_b32 s22, 0x400
    s_mov_b32 s23, 0x00020000
    v_mov_b32 v12, 0
    s_getreg_b32 s31, hwreg(HW_REG_XCC_ID, 0, 3)
    s_lshl_b32 s31, s31, 14
    s_add_u32 s31, s31, s36
    s_cmp_lg_u32 s0, 0
    s_cselect_b32 s5, s5, s31
    s_cmp_ge_u32 s3, 4
    s_cbranch_scc1 L_sv2
    v_lshrrev_b32 v15, 3, v1
    v_lshlrev_b32 v15, 8, v15
    v_and_b32 v10, 7, v1
    v_lshl_add_u32 v15, v10, 4, v15
    s_lshl_b32 s30, s3, 14
    s_add_u32 s30, s30, 24704
    v_add_u32 v15, s30, v15
    ds_read_b128 v[52:55], v15 offset:0
    ds_read_b128 v[56:59], v15 offset:2048
    ds_read_b128 v[60:63], v15 offset:4096
    ds_read_b128 v[64:67], v15 offset:6144
    ds_read_b128 v[68:71], v15 offset:8192
    ds_read_b128 v[72:75], v15 offset:10240
    ds_read_b128 v[76:79], v15 offset:12288
    ds_read_b128 v[80:83], v15 offset:14336
    s_waitcnt lgkmcnt(0)
    v_bfe_u32 v10, v1, 3, 1
    v_lshlrev_b32 v10, 16, v10
    v_lshrrev_b32 v11, 4, v1
    v_lshl_add_u32 v10, v11, 11, v10
    v_and_b32 v244, 7, v1
    v_lshl_add_u32 v10, v244, 2, v10
    s_lshl_b32 s30, s3, 5
    s_add_u32 s30, s30, 24576
    v_add_u32 v10, s30, v10
    ds_read2st64_b32 v[84:85], v10 offset0:0 offset1:1
    ds_read2st64_b32 v[86:87], v10 offset0:2 offset1:3
    ds_read2st64_b32 v[88:89], v10 offset0:4 offset1:5
    ds_read2st64_b32 v[90:91], v10 offset0:6 offset1:7
    ds_read2st64_b32 v[92:93], v10 offset0:32 offset1:33
    ds_read2st64_b32 v[94:95], v10 offset0:34 offset1:35
    ds_read2st64_b32 v[96:97], v10 offset0:36 offset1:37
    ds_read2st64_b32 v[98:99], v10 offset0:38 offset1:39
    s_waitcnt lgkmcnt(0)
    ds_read2st64_b32 v[100:101], v10 offset0:64 offset1:65
    ds_read2st64_b32 v[102:103], v10 offset0:66 offset1:67
    ds_read2st64_b32 v[104:105], v10 offset0:68 offset1:69
    ds_read2st64_b32 v[106:107], v10 offset0:70 offset1:71
    ds_read2st64_b32 v[108:109], v10 offset0:96 offset1:97
    ds_read2st64_b32 v[110:111], v10 offset0:98 offset1:99
    ds_read2st64_b32 v[112:113], v10 offset0:100 offset1:101
    ds_read2st64_b32 v[114:115], v10 offset0:102 offset1:103
    v_perm_b32 v116, v85, v84, s32
    v_perm_b32 v117, v87, v86, s32
    v_perm_b32 v118, v89, v88, s32
    v_perm_b32 v119, v91, v90, s32
    v_perm_b32 v124, v85, v84, s33
    v_perm_b32 v125, v87, v86, s33
    v_perm_b32 v126, v89, v88, s33
    v_perm_b32 v127, v91, v90, s33
    v_perm_b32 v120, v93, v92, s32
    v_perm_b32 v121, v95, v94, s32
    v_perm_b32 v122, v97, v96, s32
    v_perm_b32 v123, v99, v98, s32
    v_perm_b32 v128, v93, v92, s33
    v_perm_b32 v129, v95, v94, s33
    v_perm_b32 v130, v97, v96, s33
    v_perm_b32 v131, v99, v98, s33
    s_waitcnt lgkmcnt(0)
    ds_read2st64_b32 v[84:85], v10 offset0:128 offset1:129
    ds_read2st64_b32 v[86:87], v10 offset0:130 offset1:131
    ds_read2st64_b32 v[88:89], v10 offset0:132 offset1:133
    ds_read2st64_b32 v[90:91], v10 offset0:134 offset1:135
    ds_read2st64_b32 v[92:93], v10 offset0:160 offset1:161
    ds_read2st64_b32 v[94:95], v10 offset0:162 offset1:163
    ds_read2st64_b32 v[96:97], v10 offset0:164 offset1:165
    ds_read2st64_b32 v[98:99], v10 offset0:166 offset1:167
    v_perm_b32 v132, v101, v100, s32
    v_perm_b32 v133, v103, v102, s32
    v_perm_b32 v134, v105, v104, s32
    v_perm_b32 v135, v107, v106, s32
    v_perm_b32 v140, v101, v100, s33
    v_perm_b32 v141, v103, v102, s33
    v_perm_b32 v142, v105, v104, s33
    v_perm_b32 v143, v107, v106, s33
    v_perm_b32 v136, v109, v108, s32
    v_perm_b32 v137, v111, v110, s32
    v_perm_b32 v138, v113, v112, s32
    v_perm_b32 v139, v115, v114, s32
    v_perm_b32 v144, v109, v108, s33
    v_perm_b32 v145, v111, v110, s33
    v_perm_b32 v146, v113, v112, s33
    v_perm_b32 v147, v115, v114, s33
    s_waitcnt lgkmcnt(0)
    ds_read2st64_b32 v[100:101], v10 offset0:192 offset1:193
    ds_read2st64_b32 v[102:103], v10 offset0:194 offset1:195
    ds_read2st64_b32 v[104:105], v10 offset0:196 offset1:197
    ds_read2st64_b32 v[106:107], v10 offset0:198 offset1:199
    ds_read2st64_b32 v[108:109], v10 offset0:224 offset1:225
    ds_read2st64_b32 v[110:111], v10 offset0:226 offset1:227
    ds_read2st64_b32 v[112:113], v10 offset0:228 offset1:229
    ds_read2st64_b32 v[114:115], v10 offset0:230 offset1:231
    v_perm_b32 v148, v85, v84, s32
    v_perm_b32 v149, v87, v86, s32
    v_perm_b32 v150, v89, v88, s32
    v_perm_b32 v151, v91, v90, s32
    v_perm_b32 v156, v85, v84, s33
    v_perm_b32 v157, v87, v86, s33
    v_perm_b32 v158, v89, v88, s33
    v_perm_b32 v159, v91, v90, s33
    v_perm_b32 v152, v93, v92, s32
    v_perm_b32 v153, v95, v94, s32
    v_perm_b32 v154, v97, v96, s32
    v_perm_b32 v155, v99, v98, s32
    v_perm_b32 v160, v93, v92, s33
    v_perm_b32 v161, v95, v94, s33
    v_perm_b32 v162, v97, v96, s33
    v_perm_b32 v163, v99, v98, s33
    s_waitcnt lgkmcnt(0)
    v_perm_b32 v164, v101, v100, s32
    v_perm_b32 v165, v103, v102, s32
    v_perm_b32 v166, v105, v104, s32
    v_perm_b32 v167, v107, v106, s32
    v_perm_b32 v172, v101, v100, s33
    v_perm_b32 v173, v103, v102, s33
    v_perm_b32 v174, v105, v104, s33
    v_perm_b32 v175, v107, v106, s33
    v_perm_b32 v168, v109, v108, s32
    v_perm_b32 v169, v111, v110, s32
    v_perm_b32 v170, v113, v112, s32
    v_perm_b32 v171, v115, v114, s32
    v_perm_b32 v176, v109, v108, s33
    v_perm_b32 v177, v111, v110, s33
    v_perm_b32 v178, v113, v112, s33
    v_perm_b32 v179, v115, v114, s33
L_sv2:
    s_barrier
    s_branch L_tail
.p2align 12
L_tail:
    v_lshrrev_b32 v11, 4, v1
    v_and_b32 v10, 15, v1
    v_lshlrev_b32 v15, 14, v11
    v_lshl_add_u32 v15, v10, 4, v15
    v_lshl_add_u32 v13, v11, 2, v10
    v_and_b32 v13, 15, v13
    v_lshlrev_b32 v13, 4, v13
    s_lshl_b32 s30, s41, 16
    s_lshl_b32 s31, s3, 8
    s_add_u32 s30, s30, s31
    s_add_u32 s49, s30, 262144
    s_add_u32 s50, s30, 266240
    s_add_u32 s51, s30, 270336
    s_add_u32 s28, s30, 274432
    s_lshl_b32 s30, s41, 10
    s_lshr_b32 s31, s3, 1
    s_lshl_b32 s31, s31, 8
    s_add_u32 s30, s30, s31
    s_add_u32 s29, s30, 196608
    v_mov_b32 v84, -1
    v_mov_b32 v85, -1
    v_mov_b32 v86, -1
    v_mov_b32 v87, -1
    v_mov_b32 v88, -1
    v_mov_b32 v89, -1
    v_mov_b32 v90, -1
    v_mov_b32 v91, -1
    v_mov_b32 v92, -1
    v_mov_b32 v93, -1
    v_mov_b32 v94, -1
    v_mov_b32 v95, -1
    v_mov_b32 v96, -1
    v_mov_b32 v97, -1
    v_mov_b32 v98, -1
    v_mov_b32 v99, -1
    v_mov_b32 v100, -1
    v_mov_b32 v101, -1
    v_mov_b32 v102, -1
    v_mov_b32 v103, -1
    v_mov_b32 v104, -1
    v_mov_b32 v105, -1
    v_mov_b32 v106, -1
    v_mov_b32 v107, -1
    v_mov_b32 v108, -1
    v_mov_b32 v109, -1
    v_mov_b32 v110, -1
    v_mov_b32 v111, -1
    v_mov_b32 v112, -1
    v_mov_b32 v113, -1
    v_mov_b32 v114, -1
    v_mov_b32 v115, -1
    v_and_b32 v6, 0x180, v2
    v_bfe_u32 v10, v2, 2, 2
    v_lshl_add_u32 v6, v10, 5, v6
    v_and_b32 v10, 3, v2
    v_lshl_add_u32 v6, v10, 3, v6
    v_bfe_u32 v10, v2, 4, 3
    v_add_u32 v253, v6, v10
    v_and_b32 v10, 12, v253
    v_and_b32 v6, -15, v253
    v_lshl_add_u32 v6, v6, 1, v10
    v_and_b32 v10, 2, v253
    v_lshl_add_u32 v6, v10, 3, v6
    v_bfe_u32 v252, v1, 1, 1
    v_mul_u32_u24 v252, 0xaaaa, v252
    v_add_u32 v252, 0x4444, v252
    v_mov_b32 v244, 0
    v_mov_b32 v245, 0
    v_mov_b32 v246, 0
    v_mov_b32 v247, 0
    v_mov_b32 v248, 0
    v_mov_b32 v249, 0
    v_mov_b32 v250, 0
    v_mov_b32 v251, 0
    v_mov_b32 v10, 18560
    ds_write_b128 v10, v[244:247]
    v_and_b32 v8, 7, v1
    v_lshlrev_b32 v8, 4, v8
    v_lshl_add_u32 v8, v11, 8, v8
    v_bfe_u32 v10, v1, 3, 1
    v_lshl_add_u32 v8, v10, 2, v8
    s_lshr_b32 s30, s3, 1
    s_lshl_b32 s30, s30, 10
    s_and_b32 s31, s3, 1
    s_lshl_b32 s31, s31, 3
    s_add_u32 s30, s30, s31
    s_add_u32 s30, s30, 10240
    v_add_u32 v8, s30, v8
    v_and_b32 v254, 7, v1
    v_lshrrev_b32 v10, 3, v1
    v_lshl_add_u32 v254, v254, 3, v10
    s_lshl_b32 s30, s3, 6
    v_add_u32 v254, s30, v254
    v_and_b32 v10, 12, v254
    v_and_b32 v253, -15, v254
    v_lshl_add_u32 v253, v253, 1, v10
    v_and_b32 v10, 2, v254
    v_lshl_add_u32 v253, v10, 3, v253
    v_and_b32 v254, 1, v1
    v_lshlrev_b32 v254, 6, v254
    v_and_b32 v10, 16, v1
    v_lshl_add_u32 v254, v10, 1, v254
    v_and_b32 v10, 2, v1
    v_lshl_add_u32 v254, v10, 3, v254
    s_lshl_b32 s30, s3, 7
    s_add_u32 s30, s30, 18688
    v_add_u32 v254, s30, v254
    s_mov_b32 vcc_lo, 0x0f0f0f0f
    s_mov_b32 vcc_hi, 0xf0f0f0f0
    v_mov_b32 v10, 18560
    v_cndmask_b32 v254, v10, v254, vcc
    v_and_b32 v10, 7, v1
    v_lshlrev_b32 v10, 3, v10
    v_lshl_add_u32 v5, v11, 14, v10
    s_mov_b32 s40, 65536
L_s1a:
    buffer_load_dwordx4 v[32:35], v13, s[16:19], s29 offen sc1
    s_waitcnt vmcnt(0)
    v_cmp_eq_u32 s[44:45], -1, v32
    v_cmp_eq_u32 s[46:47], -1, v34
    s_and_b32 s30, s44, 0xffff
    s_bcnt1_i32_b32 s30, s30
    s_and_b32 s31, s46, 0xffff
    s_bcnt1_i32_b32 s31, s31
    s_add_u32 s30, s30, s31
    s_cmp_le_u32 s30, 20
    s_cbranch_scc1 L_s1c0
    s_cmp_lt_u32 s30, 28
    s_cbranch_scc1 L_s1a_n
    s_sleep 16
L_s1a_n:
    s_sub_u32 s40, s40, 1
    s_cmp_lg_u32 s40, 0
    s_cbranch_scc1 L_s1a
L_s1c0:
    s_mov_b64 s[64:65], -1
    s_mov_b64 s[66:67], -1
    s_mov_b64 s[68:69], -1
    s_mov_b64 s[70:71], -1
    s_mov_b64 s[72:73], -1
    s_mov_b64 s[74:75], -1
    s_mov_b64 s[76:77], -1
    s_mov_b64 s[78:79], -1
    s_mov_b64 s[80:81], -1
    s_mov_b32 s40, 65536
L_s1c:
    s_mov_b64 exec, s[64:65]
    s_cbranch_execz L_s1k0
    buffer_load_dwordx4 v[84:87], v15, s[16:19], s49 offen offset:0 sc1
L_s1k0:
    s_mov_b64 exec, s[66:67]
    s_cbranch_execz L_s1k1
    buffer_load_dwordx4 v[88:91], v15, s[16:19], s49 offen offset:2048 sc1
L_s1k1:
    s_mov_b64 exec, s[68:69]
    s_cbranch_execz L_s1k2
    buffer_load_dwordx4 v[92:95], v15, s[16:19], s50 offen offset:0 sc1
L_s1k2:
    s_mov_b64 exec, s[70:71]
    s_cbranch_execz L_s1k3
    buffer_load_dwordx4 v[96:99], v15, s[16:19], s50 offen offset:2048 sc1
L_s1k3:
    s_mov_b64 exec, s[72:73]
    s_cbranch_execz L_s1k4
    buffer_load_dwordx4 v[100:103], v15, s[16:19], s51 offen offset:0 sc1
L_s1k4:
    s_mov_b64 exec, s[74:75]
    s_cbranch_execz L_s1k5
    buffer_load_dwordx4 v[104:107], v15, s[16:19], s51 offen offset:2048 sc1
L_s1k5:
    s_mov_b64 exec, s[76:77]
    s_cbranch_execz L_s1k6
    buffer_load_dwordx4 v[108:111], v15, s[16:19], s28 offen offset:0 sc1
L_s1k6:
    s_mov_b64 exec, s[78:79]
    s_cbranch_execz L_s1k7
    buffer_load_dwordx4 v[112:115], v15, s[16:19], s28 offen offset:2048 sc1
L_s1k7:
    s_mov_b64 exec, s[80:81]
    s_cbranch_execz L_s1k8
    buffer_load_dwordx4 v[32:35], v13, s[16:19], s29 offen sc1
L_s1k8:
    s_mov_b64 exec, -1
    s_waitcnt vmcnt(0)
    v_max3_u32 v11, v84, v85, v86
    v_max_u32 v11, v11, v87
    v_cmp_eq_u32 s[64:65], -1, v11
    v_max3_u32 v10, v88, v89, v90
    v_max_u32 v10, v10, v91
    v_cmp_eq_u32 s[66:67], -1, v10
    v_max3_u32 v11, v92, v93, v94
    v_max_u32 v11, v11, v95
    v_cmp_eq_u32 s[68:69], -1, v11
    v_max3_u32 v10, v96, v97, v98
    v_max_u32 v10, v10, v99
    v_cmp_eq_u32 s[70:71], -1, v10
    v_max3_u32 v11, v100, v101, v102
    v_max_u32 v11, v11, v103
    v_cmp_eq_u32 s[72:73], -1, v11
    v_max3_u32 v10, v104, v105, v106
    v_max_u32 v10, v10, v107
    v_cmp_eq_u32 s[74:75], -1, v10
    v_max3_u32 v11, v108, v109, v110
    v_max_u32 v11, v11, v111
    v_cmp_eq_u32 s[76:77], -1, v11
    v_max3_u32 v10, v112, v113, v114
    v_max_u32 v10, v10, v115
    v_cmp_eq_u32 s[78:79], -1, v10
    v_max3_u32 v11, v32, v33, v34
    v_max_u32 v11, v11, v35
    v_cmp_eq_u32 s[80:81], -1, v11
    s_or_b64 s[44:45], s[64:65], s[66:67]
    s_or_b64 s[44:45], s[44:45], s[68:69]
    s_or_b64 s[44:45], s[44:45], s[70:71]
    s_or_b64 s[44:45], s[44:45], s[72:73]
    s_or_b64 s[44:45], s[44:45], s[74:75]
    s_or_b64 s[44:45], s[44:45], s[76:77]
    s_or_b64 s[44:45], s[44:45], s[78:79]
    s_or_b64 s[44:45], s[44:45], s[80:81]
    s_cbranch_scc0 L_s1ok
    s_sub_u32 s40, s40, 1
    s_cmp_lg_u32 s40, 0
    s_cbranch_scc1 L_s1c
L_s1ok:
    v_max_f32 v10, v32, v34
    s_nop 0
    s_nop 0
    v_max_f32_dpp v10, v10, v10 quad_perm:[1,0,3,2] row_mask:0xf bank_mask:0xf
    s_nop 1
    v_max_f32_dpp v10, v10, v10 quad_perm:[2,3,0,1] row_mask:0xf bank_mask:0xf
    s_nop 1
    v_max_f32_dpp v10, v10, v10 row_half_mirror row_mask:0xf bank_mask:0xf
    s_nop 1
    v_max_f32_dpp v10, v10, v10 row_ror:8 row_mask:0xf bank_mask:0xf
    v_mul_f32 v10, s34, v10
    v_fma_f32 v40, v32, s34, -v10
    v_fma_f32 v41, v34, s34, -v10
    v_exp_f32 v40, v40
    v_exp_f32 v41, v41
    s_nop 0
    v_mul_f32 v42, v40, v33
    v_fmac_f32 v42, v41, v35
    v_mul_f32_dpp v36, v40, v84 row_newbcast:0 row_mask:0xf bank_mask:0xf
    v_mul_f32_dpp v37, v40, v85 row_newbcast:0 row_mask:0xf bank_mask:0xf
    v_mul_f32_dpp v38, v40, v86 row_newbcast:0 row_mask:0xf bank_mask:0xf
    v_mul_f32_dpp v39, v40, v87 row_newbcast:0 row_mask:0xf bank_mask:0xf
    v_add_f32_dpp v42, v42, v42 quad_perm:[1,0,3,2] row_mask:0xf bank_mask:0xf
    v_fmac_f32_dpp v36, v41, v88 row_newbcast:0 row_mask:0xf bank_mask:0xf
    v_fmac_f32_dpp v37, v41, v89 row_newbcast:0 row_mask:0xf bank_mask:0xf
    v_fmac_f32_dpp v38, v41, v90 row_newbcast:0 row_mask:0xf bank_mask:0xf
    v_fmac_f32_dpp v39, v41, v91 row_newbcast:0 row_mask:0xf bank_mask:0xf
    v_add_f32_dpp v42, v42, v42 quad_perm:[2,3,0,1] row_mask:0xf bank_mask:0xf
    v_fmac_f32_dpp v36, v40, v92 row_newbcast:1 row_mask:0xf bank_mask:0xf
    v_fmac_f32_dpp v37, v40, v93 row_newbcast:1 row_mask:0xf bank_mask:0xf
    v_fmac_f32_dpp v38, v40, v94 row_newbcast:1 row_mask:0xf bank_mask:0xf
    v_fmac_f32_dpp v39, v40, v95 row_newbcast:1 row_mask:0xf bank_mask:0xf
    v_add_f32_dpp v42, v42, v42 row_half_mirror row_mask:0xf bank_mask:0xf
    v_fmac_f32_dpp v36, v41, v96 row_newbcast:1 row_mask:0xf bank_mask:0xf
    v_fmac_f32_dpp v37, v41, v97 row_newbcast:1 row_mask:0xf bank_mask:0xf
    v_fmac_f32_dpp v38, v41, v98 row_newbcast:1 row_mask:0xf bank_mask:0xf
    v_fmac_f32_dpp v39, v41, v99 row_newbcast:1 row_mask:0xf bank_mask:0xf
    v_add_f32_dpp v42, v42, v42 row_ror:8 row_mask:0xf bank_mask:0xf
    v_fmac_f32_dpp v36, v40, v100 row_newbcast:2 row_mask:0xf bank_mask:0xf
    v_fmac_f32_dpp v37, v40, v101 row_newbcast:2 row_mask:0xf bank_mask:0xf
    v_fmac_f32_dpp v38, v40, v102 row_newbcast:2 row_mask:0xf bank_mask:0xf
    v_fmac_f32_dpp v39, v40, v103 row_newbcast:2 row_mask:0xf bank_mask:0xf
    v_rcp_f32 v42, v42
    v_fmac_f32_dpp v36, v41, v104 row_newbcast:2 row_mask:0xf bank_mask:0xf
    v_fmac_f32_dpp v37, v41, v105 row_newbcast:2 row_mask:0xf bank_mask:0xf
    v_fmac_f32_dpp v38, v41, v106 row_newbcast:2 row_mask:0xf bank_mask:0xf
    v_fmac_f32_dpp v39, v41, v107 row_newbcast:2 row_mask:0xf bank_mask:0xf
    v_fmac_f32_dpp v36, v40, v108 row_newbcast:3 row_mask:0xf bank_mask:0xf
    v_fmac_f32_dpp v37, v40, v109 row_newbcast:3 row_mask:0xf bank_mask:0xf
    v_fmac_f32_dpp v38, v40, v110 row_newbcast:3 row_mask:0xf bank_mask:0xf
    v_fmac_f32_dpp v39, v40, v111 row_newbcast:3 row_mask:0xf bank_mask:0xf
    v_fmac_f32_dpp v36, v41, v112 row_newbcast:3 row_mask:0xf bank_mask:0xf
    v_fmac_f32_dpp v37, v41, v113 row_newbcast:3 row_mask:0xf bank_mask:0xf
    v_fmac_f32_dpp v38, v41, v114 row_newbcast:3 row_mask:0xf bank_mask:0xf
    v_fmac_f32_dpp v39, v41, v115 row_newbcast:3 row_mask:0xf bank_mask:0xf
    s_nop 1
    v_permlane32_swap_b32 v36, v37
    v_permlane32_swap_b32 v38, v39
    v_add_f32 v36, v36, v37
    v_add_f32 v38, v38, v39
    s_nop 1
    v_permlane16_swap_b32 v36, v38
    v_add_f32 v36, v36, v38
    v_mul_f32 v36, v36, v42
    v_cvt_pk_bf16_f32 v36, v36, v36
    ds_write_b16 v6, v36 offset:7168
    v_and_b32 v10, 1, v1
    v_lshlrev_b32 v10, 9, v10
    v_and_b32 v11, 2, v1
    v_lshl_add_u32 v10, v11, 3, v10
    v_lshrrev_b32 v11, 4, v1
    v_lshl_add_u32 v10, v11, 5, v10
    s_waitcnt lgkmcnt(0)
    s_barrier
    ds_read_b128 v[16:19], v10 offset:7168
    ds_read_b128 v[20:23], v10 offset:7296
    ds_read_b128 v[24:27], v10 offset:7424
    ds_read_b128 v[28:31], v10 offset:7552
    v_mov_b64 v[84:85], 0
    v_mov_b64 v[86:87], 0
    v_mov_b64 v[88:89], 0
    v_mov_b64 v[90:91], 0
    v_mov_b64 v[92:93], 0
    v_mov_b64 v[94:95], 0
    v_mov_b64 v[96:97], 0
    v_mov_b64 v[98:99], 0
    v_mov_b64 v[100:101], 0
    v_mov_b64 v[102:103], 0
    v_mov_b64 v[104:105], 0
    v_mov_b64 v[106:107], 0
    v_mov_b64 v[108:109], 0
    v_mov_b64 v[110:111], 0
    v_mov_b64 v[112:113], 0
    v_mov_b64 v[114:115], 0
    s_waitcnt lgkmcnt(3)
    v_smfmac_f32_16x16x64_bf16 v[244:247], v[16:19], v[116:123], v252
    v_smfmac_f32_16x16x64_bf16 v[248:251], v[16:19], v[124:131], v252
    s_waitcnt lgkmcnt(2)
    v_smfmac_f32_16x16x64_bf16 v[244:247], v[20:23], v[132:139], v252
    v_smfmac_f32_16x16x64_bf16 v[248:251], v[20:23], v[140:147], v252
    s_waitcnt lgkmcnt(1)
    v_smfmac_f32_16x16x64_bf16 v[244:247], v[24:27], v[148:155], v252
    v_smfmac_f32_16x16x64_bf16 v[248:251], v[24:27], v[156:163], v252
    s_waitcnt lgkmcnt(0)
    v_smfmac_f32_16x16x64_bf16 v[244:247], v[28:31], v[164:171], v252
    v_smfmac_f32_16x16x64_bf16 v[248:251], v[28:31], v[172:179], v252
    s_getreg_b32 s31, hwreg(HW_REG_XCC_ID, 0, 3)
    s_lshl_b32 s31, s31, 14
    s_lshl_b32 s30, s3, 8
    s_add_u32 s30, s30, s31
    s_add_u32 s49, s30, 1048576
    s_add_u32 s50, s30, 1056768
    v_and_b32 v10, 15, v1
    v_lshlrev_b32 v10, 4, v10
    v_lshl_add_u32 v15, v11, 11, v10
    s_mov_b32 s40, 65536
    v_pk_add_f32 v[244:245], v[244:245], v[246:247]
    v_pk_add_f32 v[248:249], v[248:249], v[250:251]
    s_cmp_lg_u32 s0, 0
    v_add_f32_dpp v36, v245, v244 row_ror:8 row_mask:0xf bank_mask:0xf
    v_add_f32_dpp v37, v249, v248 row_ror:8 row_mask:0xf bank_mask:0xf
    s_cbranch_scc1 L_y1slow
    s_mov_b64 exec, 0xff
    buffer_store_dwordx2 v[36:37], v5, s[16:19], s5 offen
L_y1j:
    s_mov_b64 exec, -1
L_s3p:
    buffer_load_dwordx4 v[116:119], v15, s[16:19], s49 offen sc1
    buffer_load_dwordx4 v[120:123], v15, s[16:19], s50 offen offset:0 sc1
L_s3p_k:
    s_mov_b64 exec, -1
    s_waitcnt vmcnt(0)
    v_max3_u32 v10, v116, v117, v118
    v_max3_u32 v11, v119, v120, v121
    v_max3_u32 v10, v10, v122, v123
    v_max_u32 v10, v10, v11
    v_cmp_eq_u32 vcc, -1, v10
    s_cbranch_vccz L_s3p_ok
    s_mov_b64 exec, vcc
    s_sub_u32 s40, s40, 1
    s_cmp_lg_u32 s40, 0
    s_cbranch_scc1 L_s3p
    s_mov_b64 exec, -1
L_s3p_ok:
    v_pk_add_f32 v[36:37], v[116:117], v[120:121]
    v_pk_add_f32 v[38:39], v[118:119], v[122:123]
    s_nop 1
    v_permlane32_swap_b32 v36, v37
    v_permlane32_swap_b32 v38, v39
    v_add_f32 v36, v36, v37
    v_add_f32 v38, v38, v39
    s_nop 1
    v_permlane16_swap_b32 v36, v38
    v_add_f32 v36, v36, v38
    v_cvt_pk_bf16_f32 v36, v36, v36
    v_and_b32 v36, 0xffff0000, v36
    v_mul_f32 v36, v36, v45
    v_cvt_pk_bf16_f32 v36, v36, v36
    v_and_b32 v36, 0xffff0000, v36
    v_add_f32 v36, v36, v44
    v_cvt_pk_bf16_f32 v36, v36, v36
    v_and_b32 v36, 0xffff0000, v36
    v_lshlrev_b32 v10, 2, v2
    s_cmp_ge_u32 s43, 28
    s_cbranch_scc1 L_s3skip
    v_mul_f32 v38, v36, v46
    v_cvt_pk_bf16_f32 v39, v38, v38
    v_and_b32 v39, 0xffff0000, v39
    v_sub_f32 v38, v38, v39
    ds_write_b16_d16_hi v7, v39 offset:8192
    ds_write_b16_d16_hi v7, v38 offset:8320
    ds_read_b128 v[16:19], v9 offset:8192
    ds_write_b32 v10, v36 offset:19712
    v_mul_f32 v37, v36, v36
    s_nop 0
    v_add_f32_dpp v36, v36, v36 quad_perm:[1,0,3,2] row_mask:0xf bank_mask:0xf
    v_add_f32_dpp v37, v37, v37 quad_perm:[1,0,3,2] row_mask:0xf bank_mask:0xf
    s_nop 0
    v_add_f32_dpp v36, v36, v36 quad_perm:[2,3,0,1] row_mask:0xf bank_mask:0xf
    v_add_f32_dpp v37, v37, v37 quad_perm:[2,3,0,1] row_mask:0xf bank_mask:0xf
    s_nop 0
    v_add_f32_dpp v36, v36, v36 row_half_mirror row_mask:0xf bank_mask:0xf
    v_add_f32_dpp v37, v37, v37 row_half_mirror row_mask:0xf bank_mask:0xf
    s_nop 0
    v_add_f32_dpp v36, v36, v36 row_ror:8 row_mask:0xf bank_mask:0xf
    v_add_f32_dpp v37, v37, v37 row_ror:8 row_mask:0xf bank_mask:0xf
    v_mov_b64 v[164:165], 0
    v_mov_b64 v[166:167], 0
    v_mov_b64 v[168:169], 0
    v_mov_b64 v[170:171], 0
    v_mov_b64 v[172:173], 0
    v_mov_b64 v[174:175], 0
    v_mov_b64 v[176:177], 0
    v_mov_b64 v[178:179], 0
    s_waitcnt lgkmcnt(1)
    v_smfmac_f32_16x16x64_bf16 v[84:87], v[16:19], v[180:187], v252
    v_permlane32_swap_b32 v36, v37
    v_smfmac_f32_16x16x64_bf16 v[88:91], v[16:19], v[188:195], v252
    v_add_f32 v36, v36, v37
    v_smfmac_f32_16x16x64_bf16 v[92:95], v[16:19], v[196:203], v252
    v_mov_b32 v37, v36
    v_smfmac_f32_16x16x64_bf16 v[96:99], v[16:19], v[204:211], v252
    v_lshrrev_b32 v11, 3, v1
    v_smfmac_f32_16x16x64_bf16 v[100:103], v[16:19], v[212:219], v252
    s_lshl_b32 s30, s3, 3
    v_smfmac_f32_16x16x64_bf16 v[104:107], v[16:19], v[220:227], v252
    v_permlane16_swap_b32 v36, v37
    v_smfmac_f32_16x16x64_bf16 v[108:111], v[16:19], v[228:235], v252
    v_add_f32 v36, v36, v37
    v_smfmac_f32_16x16x64_bf16 v[112:115], v[16:19], v[236:243], v252
    v_add_u32 v11, s30, v11
    s_mov_b32 exec_lo, 1
    s_mov_b32 exec_hi, 1
    ds_write_b32 v11, v36 offset:18432
    s_mov_b64 exec, -1
    v_pk_add_f32 v[84:85], v[84:85], v[86:87]
    v_pk_add_f32 v[88:89], v[88:89], v[90:91]
    v_pk_add_f32 v[92:93], v[92:93], v[94:95]
    v_pk_add_f32 v[96:97], v[96:97], v[98:99]
    v_pk_add_f32 v[100:101], v[100:101], v[102:103]
    v_pk_add_f32 v[104:105], v[104:105], v[106:107]
    v_pk_add_f32 v[108:109], v[108:109], v[110:111]
    v_pk_add_f32 v[112:113], v[112:113], v[114:115]
    v_add_f32_dpp v24, v85, v84 quad_perm:[0,1,2,3] row_mask:0x1 bank_mask:0xf
    v_add_f32_dpp v25, v89, v88 quad_perm:[0,1,2,3] row_mask:0x1 bank_mask:0xf
    v_add_f32_dpp v24, v93, v92 quad_perm:[0,1,2,3] row_mask:0x2 bank_mask:0xf
    v_add_f32_dpp v25, v97, v96 quad_perm:[0,1,2,3] row_mask:0x2 bank_mask:0xf
    v_add_f32_dpp v24, v101, v100 quad_perm:[0,1,2,3] row_mask:0x4 bank_mask:0xf
    v_add_f32_dpp v25, v105, v104 quad_perm:[0,1,2,3] row_mask:0x4 bank_mask:0xf
    v_add_f32_dpp v24, v109, v108 quad_perm:[0,1,2,3] row_mask:0x8 bank_mask:0xf
    v_add_f32_dpp v25, v113, v112 quad_perm:[0,1,2,3] row_mask:0x8 bank_mask:0xf
    ds_write2_b32 v8, v24, v25 offset0:0 offset1:32
    v_and_b32 v10, 7, v1
    v_lshlrev_b32 v10, 3, v10
    s_waitcnt lgkmcnt(0)
    s_barrier
    ds_read_b64 v[132:133], v10 offset:18432
    ds_read_b128 v[84:87], v4 offset:10240
    ds_read_b128 v[88:91], v4 offset:11264
    ds_read_b128 v[92:95], v4 offset:12288
    ds_read_b128 v[96:99], v4 offset:13312
    s_waitcnt lgkmcnt(4)
    v_add_f32_dpp v132, v132, v132 quad_perm:[1,0,3,2] row_mask:0xf bank_mask:0xf
    v_add_f32_dpp v133, v133, v133 quad_perm:[1,0,3,2] row_mask:0xf bank_mask:0xf
    s_nop 0
    v_add_f32_dpp v132, v132, v132 quad_perm:[2,3,0,1] row_mask:0xf bank_mask:0xf
    v_add_f32_dpp v133, v133, v133 quad_perm:[2,3,0,1] row_mask:0xf bank_mask:0xf
    s_nop 0
    v_add_f32_dpp v132, v132, v132 row_half_mirror row_mask:0xf bank_mask:0xf
    v_add_f32_dpp v133, v133, v133 row_half_mirror row_mask:0xf bank_mask:0xf
    v_mul_f32 v36, 0x3b000000, v132
    v_mul_f32 v37, 0x3b000000, v133
    v_fma_f32 v37, -v36, v36, v37
    v_max_f32 v37, 0, v37
    v_add_f32 v37, 0x3727c5ac, v37
    v_rsq_f32 v37, v37
    s_waitcnt lgkmcnt(0)
    v_pk_add_f32 v[84:85], v[84:85], v[92:93]
    v_pk_add_f32 v[86:87], v[86:87], v[94:95]
    v_pk_add_f32 v[88:89], v[88:89], v[96:97]
    v_pk_add_f32 v[90:91], v[90:91], v[98:99]
    v_pk_add_f32 v[84:85], v[84:85], v[88:89]
    v_pk_add_f32 v[86:87], v[86:87], v[90:91]
    v_pk_add_f32 v[84:85], v[84:85], v[86:87]
    v_fma_f32 v84, -v36, v48, v84
    v_fma_f32 v85, -v36, v49, v85
    v_fma_f32 v84, v84, v37, v50
    v_fma_f32 v85, v85, v37, v51
    v_cvt_pk_bf16_f32 v10, v84, v85
    v_lshlrev_b32 v24, 16, v10
    v_and_b32 v25, 0xffff0000, v10
    v_mul_f32 v26, v24, v24
    v_mul_f32 v26, 0x3d372713, v26
    v_fma_f32 v26, v26, v24, v24
    v_mul_f32 v26, 0xc0135761, v26
    v_exp_f32 v26, v26
    s_nop 0
    v_add_f32 v26, 1.0, v26
    v_rcp_f32 v26, v26
    s_nop 0
    v_mul_f32 v26, v26, v24
    v_cvt_pk_bf16_f32 v26, v26, v26
    v_and_b32 v26, 0xffff0000, v26
    v_mul_f32 v26, v26, v25
    v_cvt_pk_bf16_f32 v26, v26, v26
    ds_write_b16 v253, v26 offset:18688
    ds_read_b128 v[16:19], v254
    s_waitcnt lgkmcnt(0)
    v_smfmac_f32_16x16x64_bf16 v[164:167], v[16:19], v[52:59], v252
    v_smfmac_f32_16x16x64_bf16 v[168:171], v[16:19], v[60:67], v252
    v_smfmac_f32_16x16x64_bf16 v[172:175], v[16:19], v[68:75], v252
    v_smfmac_f32_16x16x64_bf16 v[176:179], v[16:19], v[76:83], v252
    s_nop 4
    v_pk_add_f32 v[164:165], v[164:165], v[166:167]
    v_pk_add_f32 v[168:169], v[168:169], v[170:171]
    v_pk_add_f32 v[172:173], v[172:173], v[174:175]
    v_pk_add_f32 v[176:177], v[176:177], v[178:179]
    v_add_f32_dpp v24, v165, v164 row_ror:8 row_mask:0xf bank_mask:0xf
    v_add_f32_dpp v25, v169, v168 row_ror:8 row_mask:0xf bank_mask:0xf
    v_add_f32_dpp v26, v173, v172 row_ror:8 row_mask:0xf bank_mask:0xf
    v_add_f32_dpp v27, v177, v176 row_ror:8 row_mask:0xf bank_mask:0xf
    s_mov_b64 exec, 0x00ff00ff
    s_cmp_lg_u32 s0, 0
    s_cbranch_scc1 L_y2slow
    buffer_store_dwordx4 v[24:27], v14, s[16:19], s37 offen
L_y2j:
    s_mov_b64 exec, -1
    s_branch L_s4
L_y1slow:
    s_mov_b32 exec_lo, 0x00ff00ff
    s_mov_b32 exec_hi, 0x00ff00ff
    buffer_store_dwordx2 v[36:37], v5, s[16:19], s36 offen sc1
    buffer_store_dwordx2 v[36:37], v5, s[16:19], s5 offen sc1
    s_waitcnt vmcnt(0)
    s_branch L_y1j
L_y2slow:
    buffer_store_dwordx4 v[24:27], v14, s[16:19], s37 offen sc1
    s_waitcnt vmcnt(0)
    s_branch L_y2j
L_s3skip:
    ds_write_b32 v10, v36 offset:19712
    s_waitcnt lgkmcnt(0)
    s_barrier
L_s4:
    s_cmp_lg_u32 s3, 0
    s_cbranch_scc1 L_end
    v_lshlrev_b32 v10, 2, v3
    ds_read_b32 v44, v10 offset:19712
    s_lshl_b32 s30, s43, 11
    s_add_u32 s49, s30, 131072
    v_mov_b32 v124, -1
    v_mov_b32 v125, -1
    v_mov_b32 v126, -1
    v_mov_b32 v127, -1
    v_mov_b32 v128, 0
    v_mov_b32 v129, 0
    v_mov_b32 v130, 0
    v_mov_b32 v131, 0
    s_mov_b32 s46, -1
    s_mov_b32 s47, 0xffff
    s_mov_b64 exec, s[46:47]
    v_mov_b32 v128, -1
    v_mov_b32 v129, -1
    v_mov_b32 v130, -1
    v_mov_b32 v131, -1
    s_mov_b64 exec, -1
    s_mov_b32 s40, 65536
L_s4p:
    buffer_load_dwordx4 v[124:127], v4, s[16:19], s49 offen sc1
    s_and_b64 exec, exec, s[46:47]
    s_cbranch_execz L_s4p_k
    buffer_load_dwordx4 v[128:131], v4, s[16:19], s49 offen offset:1024 sc1
L_s4p_k:
    s_mov_b64 exec, -1
    s_waitcnt vmcnt(0)
    v_max3_u32 v10, v124, v125, v126
    v_max3_u32 v11, v127, v128, v129
    v_max3_u32 v10, v10, v130, v131
    v_max_u32 v10, v10, v11
    v_cmp_eq_u32 vcc, -1, v10
    s_cbranch_vccz L_s4p_ok
    s_mov_b64 exec, vcc
    s_sub_u32 s40, s40, 1
    s_cmp_lg_u32 s40, 0
    s_cbranch_scc1 L_s4p
    s_mov_b64 exec, -1
L_s4p_ok:
    v_pk_add_f32 v[36:37], v[124:125], v[128:129]
    v_pk_add_f32 v[38:39], v[126:127], v[130:131]
    s_nop 1
    v_permlane32_swap_b32 v36, v37
    v_permlane32_swap_b32 v38, v39
    v_add_f32 v36, v36, v37
    v_add_f32 v38, v38, v39
    s_nop 1
    v_permlane16_swap_b32 v36, v38
    v_add_f32 v36, v36, v38
    v_lshlrev_b32 v11, 1, v3
    s_nop 0
    v_add_f32_dpp v36, v36, v36 row_ror:4 row_mask:0xf bank_mask:0xf
    s_nop 1
    v_add_f32_dpp v36, v36, v36 row_ror:8 row_mask:0xf bank_mask:0xf
    v_cvt_pk_bf16_f32 v36, v36, v36
    v_and_b32 v36, 0xffff0000, v36
    v_mul_f32 v36, v36, v47
    v_cvt_pk_bf16_f32 v36, v36, v36
    v_and_b32 v36, 0xffff0000, v36
    s_waitcnt lgkmcnt(0)
    v_add_f32 v36, v36, v44
    v_cvt_pk_bf16_f32 v36, v36, v36
    s_mov_b32 exec_lo, 0x000f000f
    s_mov_b32 exec_hi, 0x000f000f
    buffer_store_short v36, v11, s[20:23], 0 offen
    s_mov_b64 exec, -1
    s_cmp_lg_u32 s43, 0
    s_cbranch_scc1 L_noep
    v_mov_b32 v10, s39
    s_mov_b64 exec, 1
    buffer_store_dword v10, v12, s[16:19], 0 offen sc1
    s_mov_b64 exec, -1
L_noep:
L_fin:
L_end:
s_endpgm
.section .rodata,"a"
.p2align 6
.amdhsa_kernel adaLN_cond__gqa_block_cached__geglu_ffn__decode_kernel
  .amdhsa_next_free_vgpr 256
  .amdhsa_next_free_sgpr 102
  .amdhsa_accum_offset 256
  .amdhsa_group_segment_fixed_size 0
  .amdhsa_kernarg_size 112
  .amdhsa_user_sgpr_count 2
  .amdhsa_user_sgpr_kernarg_segment_ptr 1
  .amdhsa_system_sgpr_workgroup_id_x 1
.end_amdhsa_kernel
```
